```python
import torch

def _softmax(x, axis=-1):
    return torch.softmax(x, dim=axis)
def _gelu(x):
    return torch.nn.functional.gelu(x, approximate="tanh")
def _silu(x):
    return torch.nn.functional.silu(x)
def _sigmoid(x):
    return torch.sigmoid(x)
def _layernorm(x, axis=-1, eps=1e-5):
    m = x.mean(dim=axis, keepdim=True)
    v = x.var(dim=axis, keepdim=True, unbiased=False)
    return (x - m) / torch.sqrt(v + eps)
def _scatter_add(tgt, idx, src, axis=0):
    return tgt.clone().index_add_(axis, idx, src)
def _segment_sum(src, seg, n):
    out = torch.zeros((n,) + src.shape[1:], dtype=src.dtype)
    return out.index_add_(0, seg, src)
def _pad(x, pw):
    flat = tuple(v for pair in reversed(pw) for v in pair)
    return torch.nn.functional.pad(x, flat)

kernel_name = 'standalone__mpnn_edge_mlp__graph'

def setup_inputs():

    _w = (lambda a: (lambda t: t.to(torch.bfloat16) if t.is_floating_point() else t)(torch.as_tensor(a)))
    N, deg, D, De = 12500, 64, 64, max(4, 1)
    E = N * deg
    return {
        "x": _w((lambda *s: torch.randn(*s, dtype=torch.bfloat16) * 0.05)(N, D)),
        "e_attr": _w((lambda *s: torch.randn(*s, dtype=torch.bfloat16) * 0.4)(E, De)),
        "src": _w((lambda lo, hi, *s: torch.randint(lo, hi, s))(0, N, E).to(torch.int64)),
        "dst": _w((lambda lo, hi, *s: torch.randint(lo, hi, s))(0, N, E).to(torch.int64)),
        "w_msg": _w((lambda *s: torch.randn(*s, dtype=torch.bfloat16) * 0.4)(2 * D + De, D)),
        "w_upd": _w((lambda *s: torch.randn(*s, dtype=torch.bfloat16) * 0.05)(2 * D, D)),
    }

def reference(x, e_attr, src, dst, w_msg, w_upd):
    N, D = x.shape
    m_in = torch.concatenate([x[src], x[dst], e_attr], axis=-1)
    msg = _silu(m_in @ w_msg)
    agg = _segment_sum(msg, dst, N)
    return _silu(torch.concatenate([x, agg], axis=-1) @ w_upd)
```

```asm
; @launch grid=(256,1,1) block=(512,1,1) lds=163840
.amdgcn_target "amdgcn-amd-amdhsa--gfx950"
.text
.p2align 12
.fill 832, 4, 0xbf810000
.p2align 8
.globl standalone__mpnn_edge_mlp__graph_kernel
.type standalone__mpnn_edge_mlp__graph_kernel,@function
standalone__mpnn_edge_mlp__graph_kernel:
    s_cmp_ge_u32 s2, 256
    s_cbranch_scc1 K_END
    s_load_dwordx8 s[4:11], s[0:1], 0
    s_load_dwordx2 s[14:15], s[0:1], 64
    s_load_dwordx4 s[40:43], s[0:1], 32
    s_load_dwordx2 s[12:13], s[0:1], 48
    s_getpc_b64 s[16:17]
K_PC:
    s_lshr_b32 s3, s2, 3
    s_and_b32 s92, s3, 15
    s_lshl_b32 s92, s92, 7
    v_lshl_add_u32 v252, v0, 11, s92
    v_cmpx_gt_u32 vcc, K_LAST-K_PC, v252
    s_cbranch_execz K_CPF
    v_mov_b32 v253, 0
    v_lshl_add_u64 v[252:253], v[252:253], 0, s[16:17]
    global_load_dword v184, v[252:253], off
    s_nop 0
K_CPF:
    s_mov_b64 exec, -1
    s_and_b32 s2, s2, 7
    s_lshl_b32 s2, s2, 5
    s_add_u32 s2, s2, s3
    v_lshrrev_b32 v251, 6, v0
    v_and_b32 v1, 63, v0
    v_lshlrev_b32 v2, 4, v0
    v_readfirstlane_b32 s80, v251
    s_mul_i32 s92, s2, 3140
    s_min_u32 s92, s92, 800000
    s_sub_u32 s95, 800000, s92
    s_min_u32 s95, s95, 3140
    s_lshl_b32 s92, s92, 2
    s_lshl_b32 s93, s95, 2
    s_mov_b32 s100, 8192
    v_lshlrev_b32 v251, 2, v0
    v_mov_b32 v252, 0
    ds_write_b32 v251, v252 offset:24576
    v_and_b32 v100, 56, v0
    v_lshlrev_b32 v100, 1, v100
    v_xor_b32 v100, v100, v2
    v_and_b32 v101, 16, v0
    v_lshlrev_b32 v101, 2, v101
    v_xor_b32 v101, v101, v2
    s_lshl_b32 s101, s80, 10
    s_mul_i32 s94, s2, 6272
    s_sub_u32 s87, 1600000, s94
    s_min_u32 s87, s87, 6272
    s_mov_b32 s51, 0x00020000
    s_mov_b32 s39, 0x00020000
    s_mov_b32 s55, 0x00020000
    s_mov_b32 s50, s93
    s_mov_b32 s54, s93
    s_mov_b32 s38, s87
    s_waitcnt lgkmcnt(0)
    s_add_u32 s48, s10, s92
    s_addc_u32 s49, s11, 0
    buffer_load_dwordx4 v[8:11], v2, s[48:51], 0 offen
    buffer_load_dwordx4 v[12:15], v2, s[48:51], s100 offen
    s_add_u32 s36, s4, s94
    s_addc_u32 s37, s5, 0
    s_add_u32 s52, s8, s92
    s_addc_u32 s53, s9, 0
    s_mov_b32 s44, s42
    s_mov_b32 s45, s43
    s_mov_b32 s46, 16384
    s_mov_b32 s47, 0x00020000
    s_mov_b32 s42, 16896
    s_mov_b32 s43, 0x00020000
    s_barrier
    buffer_load_dwordx4 v[16:19], v2, s[52:55], 0 offen
    buffer_load_dwordx4 v[20:23], v2, s[52:55], s100 offen
    s_add_u32 s32, s12, s94
    s_addc_u32 s33, s13, 0
    s_mov_b32 s34, s87
    s_mov_b32 s35, 0x00020000
    s_add_u32 s94, s94, 13631488
    s_add_u32 s72, s14, s94
    s_addc_u32 s73, s15, 0
    s_mov_b32 s74, s87
    s_mov_b32 s75, 0x00020000
    s_mul_i32 s94, s2, 12800
    s_add_u32 s60, s14, s94
    s_addc_u32 s61, s15, 0
    s_mov_b32 s62, s93
    s_mov_b32 s63, 0x00020000
    s_add_u32 s62, s62, 127
    s_and_b32 s62, s62, 0xffffff80
    s_lshl_b32 s92, s92, 1
    s_lshl_b32 s93, s93, 1
    s_add_u32 s56, s6, s92
    s_addc_u32 s57, s7, 0
    s_mov_b32 s58, s93
    s_mov_b32 s59, 0x00020000
    s_lshl_b32 s94, s94, 1
    s_add_u32 s94, s94, 4194304
    s_add_u32 s64, s14, s94
    s_addc_u32 s65, s15, 0
    s_mov_b32 s66, s93
    s_mov_b32 s67, 0x00020000
    s_add_u32 s66, s66, 127
    s_and_b32 s66, s66, 0xffffff80
    s_add_u32 s16, s14, 13107200
    s_addc_u32 s17, s15, 0
    s_mov_b32 s18, 4
    s_mov_b32 s19, 0x00020000
    s_and_b32 s92, s80, 3
    s_min_u32 s94, s92, 1
    s_mul_i32 s92, s92, 12
    s_add_u32 s92, s92, s94
    s_sub_u32 s94, 13, s94
    v_and_b32 v253, 15, v1
    v_cmp_gt_u32 s[90:91], s94, v253
    v_and_b32 v254, 48, v1
    v_add_u32 v255, s92, v253
    v_lshl_add_u32 v247, v255, 7, v254
    v_lshrrev_b32 v253, 2, v1
    v_lshlrev_b32 v254, 4, v1
    v_and_b32 v254, 48, v254
    s_lshr_b32 s92, s80, 2
    s_lshl_b32 s92, s92, 6
    v_lshrrev_b32 v102, 3, v247
    v_and_b32 v102, 0x70, v102
    v_xor_b32 v102, v102, v247
    v_add_u32 v102, 110592, v102
    v_xor_b32 v103, 64, v102
    v_and_b32 v252, 12, v253
    v_add_u32 v253, v253, v252
    v_lshl_add_u32 v246, v253, 7, v254
    v_and_b32 v252, 8, v1
    v_lshl_add_u32 v246, v252, 3, v246
    v_add_u32 v246, 155648, v246
    v_xor_b32 v177, 64, v246
    v_xor_b32 v98, s92, v246
    v_add_u32 v98, 0xfffe4800, v98
    v_xor_b32 v120, s92, v102
    v_add_u32 v121, 139264, v100
    v_mov_b32 v69, 4
    v_lshlrev_b32 v70, 16, v0
    s_lshr_b32 s92, s95, 2
    v_cmp_gt_u32 s[76:77], s92, v0
    s_sub_i32 s92, s92, 512
    v_cmp_gt_i32 s[78:79], s92, v0
    s_mul_i32 s92, s2, 49
    v_add_lshl_u32 v233, v1, s92, 2
    v_and_b32 v233, 0xfc, v233
    v_mul_u32_u24 v232, 448, v1
    v_add_u32 v232, 2576, v232
    s_lshl_b32 s86, s80, 12
    s_add_u32 s86, s86, 90112
    s_movk_i32 s92, 0x3f80
    v_and_b32 v252, 1, v1
    v_lshlrev_b32 v252, 4, v252
    v_lshlrev_b32 v252, v252, s92
    v_lshrrev_b32 v253, 2, v1
    v_and_b32 v254, 32, v1
    v_lshrrev_b32 v255, 3, v254
    v_mad_i32_i24 v253, v255, -3, v253
    v_cmp_eq_u32 s[20:21], 0, v253
    v_cmp_eq_u32 s[22:23], 1, v253
    v_cmp_eq_u32 s[24:25], 2, v253
    v_cmp_eq_u32 s[26:27], 3, v253
    v_bfe_i32 v176, v1, 1, 1
    v_and_b32 v176, 0xaaaa, v176
    v_or_b32 v176, 0x4444, v176
    v_cndmask_b32 v172, 0, v252, s[20:21]
    v_cndmask_b32 v173, 0, v252, s[22:23]
    v_cndmask_b32 v174, 0, v252, s[24:25]
    v_cndmask_b32 v175, 0, v252, s[26:27]
    v_and_b32 v253, 7, v1
    v_xor_b32 v252, v255, v253
    v_lshlrev_b32 v252, 4, v252
    v_xor_b32 v189, 3072, v252
    v_xor_b32 v191, 2064, v252
    v_xor_b32 v193, 1056, v252
    v_xor_b32 v195, 48, v252
    v_and_b32 v252, 8, v1
    v_lshlrev_b32 v252, 3, v252
    v_lshl_add_u32 v251, v253, 4, s86
    v_xor_b32 v252, v252, v254
    v_xor_b32 v251, v251, v252
    v_and_b32 v252, 31, v1
    v_lshl_add_u32 v238, v252, 7, v251
    v_xor_b32 v239, 16, v238
    v_xor_b32 v240, 64, v238
    v_xor_b32 v241, 80, v238
    s_lshl_b32 s92, s80, 7
    v_lshl_add_u32 v234, v252, 2, s92
    v_and_b32 v252, 56, v1
    v_lshl_add_u32 v235, v252, 1, s92
    v_and_b32 v252, 3, v1
    v_bfe_u32 v253, v1, 2, 3
    v_lshl_add_u32 v251, v252, 3, v253
    v_and_or_b32 v252, v253, 4, v252
    v_lshrrev_b32 v253, 5, v1
    v_xor_b32 v252, v252, v253
    v_lshl_add_u32 v252, v252, 4, s86
    v_lshl_add_u32 v200, v251, 7, v252
    v_xor_b32 v201, 32, v200
    v_xor_b32 v202, 64, v200
    v_xor_b32 v203, 96, v200
    s_mov_b32 s94, 0x14e5e0a8
    v_lshlrev_b32 v255, 4, v1
    s_waitcnt vmcnt(2)
    s_add_u32 m0, s101, 110592
    s_nop 0
    buffer_load_dwordx4 v100, s[36:39], 0 offen lds
    s_mov_b64 exec, s[76:77]
    v_mul_hi_u32 v24, v8, s94
    v_and_b32 v24, 0x3fc, v24
    ds_add_rtn_u32 v32, v24, v69 offset:24576
    v_mul_hi_u32 v25, v9, s94
    v_and_b32 v25, 0x3fc, v25
    ds_add_rtn_u32 v33, v25, v69 offset:24576
    v_mul_hi_u32 v26, v10, s94
    v_and_b32 v26, 0x3fc, v26
    ds_add_rtn_u32 v34, v26, v69 offset:24576
    v_mul_hi_u32 v27, v11, s94
    v_and_b32 v27, 0x3fc, v27
    ds_add_rtn_u32 v35, v27, v69 offset:24576
    s_mov_b64 exec, s[78:79]
    s_cbranch_execz K_H1
    v_mul_hi_u32 v28, v12, s94
    v_and_b32 v28, 0x3fc, v28
    ds_add_rtn_u32 v36, v28, v69 offset:24576
    v_mul_hi_u32 v29, v13, s94
    v_and_b32 v29, 0x3fc, v29
    ds_add_rtn_u32 v37, v29, v69 offset:24576
    v_mul_hi_u32 v30, v14, s94
    v_and_b32 v30, 0x3fc, v30
    ds_add_rtn_u32 v38, v30, v69 offset:24576
    v_mul_hi_u32 v31, v15, s94
    v_and_b32 v31, 0x3fc, v31
    ds_add_rtn_u32 v39, v31, v69 offset:24576
K_H1:
    s_mov_b64 exec, -1
    s_add_u32 m0, s101, 43008
    s_nop 0
    buffer_load_dwordx4 v101, s[40:43], 0 offen lds
    buffer_load_dword v119, off, s[16:19], 0
    s_lshl_b32 s92, s80, 8
    s_add_u32 m0, s92, 75776
    v_lshlrev_b32 v251, 2, v0
    s_mov_b32 s92, 24576
    buffer_load_dword v251, s[56:59], s92 offen lds
    s_add_u32 m0, s101, 51200
    s_mov_b32 s92, 0
    buffer_load_dwordx4 v2, s[56:59], s92 offen  lds
    s_add_u32 m0, s101, 59392
    s_mov_b32 s92, 8192
    buffer_load_dwordx4 v2, s[56:59], s92 offen  lds
    s_add_u32 m0, s101, 67584
    s_mov_b32 s92, 16384
    buffer_load_dwordx4 v2, s[56:59], s92 offen  lds
    v_lshl_or_b32 v8, v8, 26, v70
    v_lshl_or_b32 v9, v9, 26, v70
    v_lshl_or_b32 v10, v10, 26, v70
    v_lshl_or_b32 v11, v11, 26, v70
    v_lshl_or_b32 v12, v12, 26, v70
    v_lshl_or_b32 v13, v13, 26, v70
    v_lshl_or_b32 v14, v14, 26, v70
    v_lshl_or_b32 v15, v15, 26, v70
    s_waitcnt lgkmcnt(0)
    s_barrier
    ds_read_b128 v[60:63], v255 offset:24576
    s_waitcnt lgkmcnt(0)
    v_add_u32 v65, v60, v61
    v_add3_u32 v68, v65, v62, v63
    v_mov_b32 v252, v68
    s_nop 1
    v_add_u32_dpp v68, v68, v68 row_shr:1 row_mask:0xf bank_mask:0xf
    s_nop 1
    v_add_u32_dpp v68, v68, v68 row_shr:2 row_mask:0xf bank_mask:0xf
    s_nop 1
    v_add_u32_dpp v68, v68, v68 row_shr:4 row_mask:0xf bank_mask:0xf
    s_nop 1
    v_add_u32_dpp v68, v68, v68 row_shr:8 row_mask:0xf bank_mask:0xf
    s_nop 1
    v_add_u32_dpp v68, v68, v68 row_bcast:15 row_mask:0xa bank_mask:0xf
    s_nop 1
    v_add_u32_dpp v68, v68, v68 row_bcast:31 row_mask:0xc bank_mask:0xf
    v_sub_u32 v64, v68, v252
    v_add_u32 v66, v64, v65
    v_add_u32 v65, v64, v60
    v_add_u32 v67, v66, v62
    ds_write_b128 v255, v[64:67] offset:25600
    s_mov_b64 exec, s[76:77]
    ds_read_b32 v24, v24 offset:25600
    ds_read_b32 v25, v25 offset:25600
    ds_read_b32 v26, v26 offset:25600
    ds_read_b32 v27, v27 offset:25600
    s_mov_b64 exec, s[78:79]
    ds_read_b32 v28, v28 offset:25600
    ds_read_b32 v29, v29 offset:25600
    ds_read_b32 v30, v30 offset:25600
    ds_read_b32 v31, v31 offset:25600
    s_mov_b64 exec, -1
    s_lshl_b32 s92, s80, 7
    v_lshl_add_u32 v252, v1, 2, s92
    ds_read2st64_b32 v[116:117], v252 offset0:96 offset1:100
    s_waitcnt vmcnt(7)
    v_or_b32 v16, v8, v16
    s_mov_b32 s92, 0x4000
    v_or3_b32 v17, v9, v17, s92
    s_mov_b32 s92, 0x8000
    v_or3_b32 v18, v10, v18, s92
    s_mov_b32 s92, 0xc000
    v_or3_b32 v19, v11, v19, s92
    s_mov_b32 s92, 0x2000000
    v_or3_b32 v20, v12, v20, s92
    s_mov_b32 s92, 0x2004000
    v_or3_b32 v21, v13, v21, s92
    s_mov_b32 s92, 0x2008000
    v_or3_b32 v22, v14, v22, s92
    s_mov_b32 s92, 0x200c000
    v_or3_b32 v23, v15, v23, s92
    s_waitcnt lgkmcnt(1)
    s_mov_b64 exec, s[76:77]
    v_add_u32 v32, v32, v24
    ds_write_b32 v32, v16 offset:26624
    v_add_u32 v33, v33, v25
    ds_write_b32 v33, v17 offset:26624
    v_add_u32 v34, v34, v26
    ds_write_b32 v34, v18 offset:26624
    v_add_u32 v35, v35, v27
    ds_write_b32 v35, v19 offset:26624
    s_mov_b64 exec, s[78:79]
    v_add_u32 v36, v36, v28
    ds_write_b32 v36, v20 offset:26624
    v_add_u32 v37, v37, v29
    ds_write_b32 v37, v21 offset:26624
    v_add_u32 v38, v38, v30
    ds_write_b32 v38, v22 offset:26624
    v_add_u32 v39, v39, v31
    ds_write_b32 v39, v23 offset:26624
    s_mov_b64 exec, -1
    s_lshl_b32 s92, s2, 10
    s_lshl_b32 s94, s80, 7
    s_add_u32 s92, s92, s94
    s_add_u32 s92, s92, 13369344
    s_add_u32 s8, s14, s92
    s_addc_u32 s9, s15, 0
    s_mov_b32 s10, 128
    s_mov_b32 s11, 0x00020000
    s_lshl_b32 s92, s2, 3
    s_add_u32 s92, s92, 12582912
    s_add_u32 s16, s14, s92
    s_addc_u32 s17, s15, 0
    s_mov_b32 s18, 524288
    s_mov_b32 s19, 0x00020000
    s_add_u32 s20, s14, 0
    s_addc_u32 s21, s15, 0
    s_mov_b32 s22, 3276800
    s_mov_b32 s23, 0x00020000
    s_add_u32 s24, s14, 4190208
    s_addc_u32 s25, s15, 0
    s_mov_b32 s26, 6557696
    s_mov_b32 s27, 0x00020000
    s_add_u32 s28, s14, 13628416
    s_addc_u32 s29, s15, 0
    s_or_b32 s29, s29, 0x800000
    s_mov_b32 s30, 12500
    s_mov_b32 s31, 0x00020000
    s_mov_b32 s81, 0
    s_mov_b32 s82, 0
    s_mov_b32 s83, 256
    s_mov_b32 s84, 0
    s_mov_b32 s85, 1
    s_lshl_b32 s13, s80, 13
    s_add_u32 s13, s13, 24576
    v_lshlrev_b32 v252, 3, v0
    s_waitcnt vmcnt(5)
    s_waitcnt lgkmcnt(0)
    s_barrier
    ds_read_b128 v[72:75], v2 offset:26624
    ds_read_b128 v[76:79], v2 offset:34816
    ds_read_b64 v[24:25], v252 offset:26624
    ds_read_b64 v[26:27], v252 offset:30720
    ds_read_b64 v[28:29], v252 offset:34816
    ds_read_b64 v[30:31], v252 offset:38912
    v_cmp_gt_u32 s[76:77], 64, v0
    s_waitcnt lgkmcnt(0)
    v_lshrrev_b32 v32, 11, v24
    v_and_b32 v32, 0x7ff8, v32
    v_lshrrev_b32 v33, 11, v25
    v_and_b32 v33, 0x7ff8, v33
    v_lshrrev_b32 v34, 11, v26
    v_and_b32 v34, 0x7ff8, v34
    v_lshrrev_b32 v35, 11, v27
    v_and_b32 v35, 0x7ff8, v35
    v_lshrrev_b32 v36, 11, v28
    v_and_b32 v36, 0x7ff8, v36
    v_lshrrev_b32 v37, 11, v29
    v_and_b32 v37, 0x7ff8, v37
    v_lshrrev_b32 v38, 11, v30
    v_and_b32 v38, 0x7ff8, v38
    v_lshrrev_b32 v39, 11, v31
    v_and_b32 v39, 0x7ff8, v39
    s_lshl_b32 s92, s2, 11
    s_lshl_b32 s94, s80, 8
    s_add_u32 s92, s92, s94
    s_add_u32 s92, s92, 12582912
    s_add_u32 s4, s14, s92
    s_addc_u32 s5, s15, 0
    s_mov_b32 s6, 256
    s_mov_b32 s7, 0x00020000
    v_lshl_or_b32 v116, v116, 16, v117
    v_lshlrev_b32 v118, 3, v1
    ds_read_b128 v[108:111], v102
    ds_read_b128 v[112:115], v103
    ds_read_b64_tr_b16 v[56:57], v98 offset:0
    ds_read_b64_tr_b16 v[58:59], v98 offset:512
    ds_read_b64_tr_b16 v[60:61], v98 offset:4096
    ds_read_b64_tr_b16 v[62:63], v98 offset:4608
    ds_read_b64_tr_b16 v[64:65], v98 offset:8
    ds_read_b64_tr_b16 v[66:67], v98 offset:520
    ds_read_b64_tr_b16 v[68:69], v98 offset:4104
    ds_read_b64_tr_b16 v[70:71], v98 offset:4616
    s_waitcnt lgkmcnt(0)
    v_mfma_f32_16x16x32_bf16 v[8:11], v[56:59], v[108:111], 0
    v_mfma_f32_16x16x32_bf16 v[12:15], v[64:67], v[108:111], 0
    v_mfma_f32_16x16x32_bf16 v[8:11], v[60:63], v[112:115], v[8:11]
    v_mfma_f32_16x16x32_bf16 v[12:15], v[68:71], v[112:115], v[12:15]
    s_add_u32 m0, s101, 90112
    s_nop 0
    buffer_load_dwordx4 v101, s[40:43], s100 offen lds
    s_add_u32 m0, s101, 102400
    s_nop 0
    buffer_load_dwordx4 v101, s[44:47], 0 offen lds
    s_lshl_b32 s92, s80, 8
    s_add_u32 m0, s92, 98304
    v_lshlrev_b32 v251, 2, v0
    s_mov_b32 s92, 16384
    buffer_load_dword v251, s[40:43], s92 offen lds
    s_add_u32 m0, s101, 155648
    s_nop 0
    buffer_load_dwordx4 v101, s[44:47], s100 offen lds
    v_mul_f32 v8, 0xbfb8aa3b, v8
    v_mul_f32 v9, 0xbfb8aa3b, v9
    v_mul_f32 v10, 0xbfb8aa3b, v10
    v_mul_f32 v11, 0xbfb8aa3b, v11
    v_mul_f32 v12, 0xbfb8aa3b, v12
    v_mul_f32 v13, 0xbfb8aa3b, v13
    v_mul_f32 v14, 0xbfb8aa3b, v14
    v_mul_f32 v15, 0xbfb8aa3b, v15
    v_cvt_pk_bf16_f32 v16, v8, v9
    v_cvt_pk_bf16_f32 v17, v10, v11
    v_cvt_pk_bf16_f32 v18, v12, v13
    v_cvt_pk_bf16_f32 v19, v14, v15
    ds_write_b128 v120, v[16:19] offset:28672
    s_waitcnt lgkmcnt(0)
    s_barrier
    ds_read_b128 v[8:11], v121
    s_waitcnt lgkmcnt(0)
    buffer_store_dwordx4 v[8:11], v2, s[72:75], 0 offen sc1
    buffer_store_dwordx4 v[72:75], v2, s[60:63], 0 offen sc1
    buffer_store_dwordx4 v[76:79], v2, s[60:63], s100 offen sc1
    s_mov_b32 s92, 0x9e3779b1
    s_waitcnt vmcnt(4) lgkmcnt(0)
    s_barrier
    ds_read_b64 v[80:81], v32 offset:51200
    ds_read_b64 v[82:83], v33 offset:51200
    ds_read_b64 v[84:85], v34 offset:51200
    ds_read_b64 v[86:87], v35 offset:51200
    ds_read_b64 v[88:89], v36 offset:51200
    ds_read_b64 v[90:91], v37 offset:51200
    s_mov_b64 exec, s[76:77]
    ds_read_b64 v[92:93], v38 offset:51200
    ds_read_b64 v[94:95], v39 offset:51200
    s_mov_b64 exec, -1
    v_mul_lo_u32 v117, v119, s92
    v_add_u32 v117, 0x7f4a7c15, v117
    v_lshlrev_b32 v119, 2, v1
    v_readfirstlane_b32 s89, v117
    v_not_b32 v96, v117
    buffer_store_dword v96, v119, s[8:11], 0 offen sc1
    s_cmp_ge_u32 s80, 4
    s_cselect_b32 s92, 0, 12288
    s_add_u32 s92, s92, 0xffff0000
    v_add_u32 v252, s92, v246
    ds_read_b64_tr_b16 v[124:125], v252 offset:0
    ds_read_b64_tr_b16 v[126:127], v252 offset:512
    ds_read_b64_tr_b16 v[128:129], v252 offset:4096
    ds_read_b64_tr_b16 v[130:131], v252 offset:4608
    ds_read_b64_tr_b16 v[132:133], v252 offset:8
    ds_read_b64_tr_b16 v[134:135], v252 offset:520
    ds_read_b64_tr_b16 v[136:137], v252 offset:4104
    ds_read_b64_tr_b16 v[138:139], v252 offset:4616
    v_add_u32 v253, s92, v177
    ds_read_b64_tr_b16 v[140:141], v253 offset:0
    ds_read_b64_tr_b16 v[142:143], v253 offset:512
    ds_read_b64_tr_b16 v[144:145], v253 offset:4096
    ds_read_b64_tr_b16 v[146:147], v253 offset:4608
    ds_read_b64_tr_b16 v[148:149], v253 offset:8
    ds_read_b64_tr_b16 v[150:151], v253 offset:520
    ds_read_b64_tr_b16 v[152:153], v253 offset:4104
    ds_read_b64_tr_b16 v[154:155], v253 offset:4616
    v_and_b32 v253, 31, v1
    v_lshlrev_b32 v253, 1, v253
    v_add_u32 v253, 98304, v253
    ds_read_u16_d16_hi v48, v253 offset:0
    ds_read_u16_d16_hi v49, v253 offset:128
    ds_read_u16_d16_hi v50, v253 offset:256
    ds_read_u16_d16_hi v51, v253 offset:384
    ds_read_u16_d16_hi v52, v253 offset:64
    ds_read_u16_d16_hi v53, v253 offset:192
    ds_read_u16_d16_hi v54, v253 offset:320
    ds_read_u16_d16_hi v55, v253 offset:448
    s_branch K_CUT1
.p2align 12
K_CUT1:
    s_waitcnt vmcnt(1)
    s_barrier
    buffer_store_dwordx2 v[116:117], v118, s[4:7], 0 offen sc1
    s_waitcnt lgkmcnt(0)
    s_mov_b32 s92, 0
    buffer_store_dwordx4 v[80:83], v2, s[64:67], s92 offen sc1
    s_mov_b32 s92, 8192
    buffer_store_dwordx4 v[84:87], v2, s[64:67], s92 offen sc1
    s_mov_b32 s92, 16384
    buffer_store_dwordx4 v[88:91], v2, s[64:67], s92 offen sc1
    s_cmp_lg_u32 s80, 0
    s_cbranch_scc1 6f
    s_mov_b32 s92, 24576
    buffer_store_dwordx4 v[92:95], v2, s[64:67], s92 offen sc1
6:
    s_waitcnt lgkmcnt(0)
    v_mfma_f32_16x16x32_bf16 v[156:159], v[124:127], v[108:111], 0
    v_mfma_f32_16x16x32_bf16 v[160:163], v[132:135], v[108:111], 0
    v_mfma_f32_16x16x32_bf16 v[164:167], v[140:143], v[108:111], 0
    v_mfma_f32_16x16x32_bf16 v[168:171], v[148:151], v[108:111], 0
    v_mfma_f32_16x16x32_bf16 v[156:159], v[128:131], v[112:115], v[156:159]
    v_mfma_f32_16x16x32_bf16 v[160:163], v[136:139], v[112:115], v[160:163]
    v_mfma_f32_16x16x32_bf16 v[164:167], v[144:147], v[112:115], v[164:167]
    v_mfma_f32_16x16x32_bf16 v[168:171], v[152:155], v[112:115], v[168:171]
    v_and_b32 v48, 0xffff0000, v48
    v_mul_f32 v48, 0xbfb8aa3b, v48
    v_and_b32 v49, 0xffff0000, v49
    v_mul_f32 v49, 0xbfb8aa3b, v49
    v_and_b32 v50, 0xffff0000, v50
    v_mul_f32 v50, 0xbfb8aa3b, v50
    v_and_b32 v51, 0xffff0000, v51
    v_mul_f32 v51, 0xbfb8aa3b, v51
    v_and_b32 v52, 0xffff0000, v52
    v_mul_f32 v52, 0xbfb8aa3b, v52
    v_and_b32 v53, 0xffff0000, v53
    v_mul_f32 v53, 0xbfb8aa3b, v53
    v_and_b32 v54, 0xffff0000, v54
    v_mul_f32 v54, 0xbfb8aa3b, v54
    v_and_b32 v55, 0xffff0000, v55
    v_mul_f32 v55, 0xbfb8aa3b, v55
    v_cvt_pk_bf16_f32 v180, v48, v49
    v_cvt_pk_bf16_f32 v181, v50, v51
    v_cvt_pk_bf16_f32 v182, v52, v53
    v_cvt_pk_bf16_f32 v183, v54, v55
    s_mov_b32 exec_lo, 0
    v_lshlrev_b32 v252, 16, v180
    v_and_b32 v253, 0xffff0000, v180
    v_sub_f32 v252, v48, v252
    v_sub_f32 v253, v49, v253
    v_cvt_pk_bf16_f32 v180, v252, v253
    v_lshlrev_b32 v252, 16, v181
    v_and_b32 v253, 0xffff0000, v181
    v_sub_f32 v252, v50, v252
    v_sub_f32 v253, v51, v253
    v_cvt_pk_bf16_f32 v181, v252, v253
    v_lshlrev_b32 v252, 16, v182
    v_and_b32 v253, 0xffff0000, v182
    v_sub_f32 v252, v52, v252
    v_sub_f32 v253, v53, v253
    v_cvt_pk_bf16_f32 v182, v252, v253
    v_lshlrev_b32 v252, 16, v183
    v_and_b32 v253, 0xffff0000, v183
    v_sub_f32 v252, v54, v252
    v_sub_f32 v253, v55, v253
    v_cvt_pk_bf16_f32 v183, v252, v253
    s_mov_b32 exec_lo, -1
    v_subrev_u32 v251, 80, v0
    v_mul_u32_u24 v254, 57, v251
    v_lshrrev_b32 v254, 9, v254
    v_mad_i32_i24 v255, v254, -10, v251
    v_max_i32 v255, 0, v255
    v_bfm_b32 v255, v255, v254
    v_mov_b32 v40, 0xfb803fff
    v_mov_b32 v41, 0xfb803fff
    v_mov_b32 v42, 0xfb803fff
    v_mov_b32 v43, 0xfb803fff
    ds_write_b128 v2, v[40:43] offset:8192
    ds_write_b128 v2, v[40:43] offset:16384
    s_cmp_ge_u32 s80, 3
    s_cbranch_scc1 1f
    s_mov_b32 s92, 0x3f800000
    v_cmpx_gt_u32 vcc, 161, v0
    v_bfe_i32 v40, v255, 0, 1
    v_bfe_i32 v254, v255, 1, 1
    v_and_b32 v40, 0x3f80, v40
    v_and_or_b32 v40, v254, s92, v40
    v_bfe_i32 v41, v255, 2, 1
    v_bfe_i32 v254, v255, 3, 1
    v_and_b32 v41, 0x3f80, v41
    v_and_or_b32 v41, v254, s92, v41
    v_bfe_i32 v42, v255, 4, 1
    v_bfe_i32 v254, v255, 5, 1
    v_and_b32 v42, 0x3f80, v42
    v_and_or_b32 v42, v254, s92, v42
    v_bfe_i32 v43, v255, 6, 1
    v_bfe_i32 v254, v255, 7, 1
    v_and_b32 v43, 0x3f80, v43
    v_and_or_b32 v43, v254, s92, v43
    v_cmpx_gt_u32 vcc, 80, v0
    v_mov_b32 v40, 2576
    v_mov_b32 v41, 2576
    v_mov_b32 v42, 2576
    v_mov_b32 v43, 2576
    s_mov_b64 exec, -1
1:
    ds_write_b128 v2, v[40:43]
    s_cmp_lg_u32 s80, 0
    s_cbranch_scc1 2f
    ds_write_b32 v233, v232 offset:0
    v_mov_b32 v254, 88960
    v_mov_b32 v40, 0
    v_mov_b32 v41, 0
    ds_write_b64 v254, v[40:41]
2:
    s_cmp_ge_u32 s80, 4
    s_cbranch_scc1 K_QW1
    v_mul_f32 v204, 0xbfb8aa3b, v156
    v_mul_f32 v205, 0xbfb8aa3b, v157
    v_mul_f32 v206, 0xbfb8aa3b, v158
    v_mul_f32 v207, 0xbfb8aa3b, v159
    v_mul_f32 v208, 0xbfb8aa3b, v160
    v_mul_f32 v209, 0xbfb8aa3b, v161
    v_mul_f32 v210, 0xbfb8aa3b, v162
    v_mul_f32 v211, 0xbfb8aa3b, v163
    v_mul_f32 v212, 0xbfb8aa3b, v164
    v_mul_f32 v213, 0xbfb8aa3b, v165
    v_mul_f32 v214, 0xbfb8aa3b, v166
    v_mul_f32 v215, 0xbfb8aa3b, v167
    v_mul_f32 v216, 0xbfb8aa3b, v168
    v_mul_f32 v217, 0xbfb8aa3b, v169
    v_mul_f32 v218, 0xbfb8aa3b, v170
    v_mul_f32 v219, 0xbfb8aa3b, v171
    s_branch K_QW2
K_QW1:
    v_mul_f32 v156, 0xbfb8aa3b, v156
    v_mul_f32 v157, 0xbfb8aa3b, v157
    v_mul_f32 v158, 0xbfb8aa3b, v158
    v_mul_f32 v159, 0xbfb8aa3b, v159
    v_mul_f32 v160, 0xbfb8aa3b, v160
    v_mul_f32 v161, 0xbfb8aa3b, v161
    v_mul_f32 v162, 0xbfb8aa3b, v162
    v_mul_f32 v163, 0xbfb8aa3b, v163
    v_mul_f32 v164, 0xbfb8aa3b, v164
    v_mul_f32 v165, 0xbfb8aa3b, v165
    v_mul_f32 v166, 0xbfb8aa3b, v166
    v_mul_f32 v167, 0xbfb8aa3b, v167
    v_mul_f32 v168, 0xbfb8aa3b, v168
    v_mul_f32 v169, 0xbfb8aa3b, v169
    v_mul_f32 v170, 0xbfb8aa3b, v170
    v_mul_f32 v171, 0xbfb8aa3b, v171
    v_lshrrev_b32 v252, 7, v247
    v_mul_u32_u24 v252, 272, v252
    v_and_b32 v253, 48, v1
    v_lshl_add_u32 v252, v253, 1, v252
    v_add_u32 v252, 122880, v252
    ds_write_b128 v252, v[156:159] offset:0
    ds_write_b128 v252, v[160:163] offset:16
    ds_write_b128 v252, v[164:167] offset:128
    ds_write_b128 v252, v[168:171] offset:144
K_QW2:
    s_waitcnt vmcnt(0) lgkmcnt(0)
    s_barrier
    buffer_store_dword v117, v119, s[8:11], 0 offen sc1
    s_cmp_ge_u32 s80, 4
    s_cbranch_scc1 K_WM1
    s_cmp_lg_u32 s80, 0
    s_cbranch_scc1 4f
    s_call_b64 s[0:1], K_STA0
4:
    s_cmp_lg_u32 s80, 1
    s_cbranch_scc1 4f
    s_call_b64 s[0:1], K_STA1
4:
    s_cmp_lg_u32 s80, 2
    s_cbranch_scc1 4f
    s_call_b64 s[0:1], K_STA2
4:
    s_cmp_lg_u32 s80, 3
    s_cbranch_scc1 4f
    s_call_b64 s[0:1], K_STA3
4:
    v_bfe_u32 v251, v1, 2, 2
    v_bfe_u32 v252, v1, 1, 1
    v_xor_b32 v252, v251, v252
    v_bfe_u32 v253, v1, 4, 1
    v_lshl_or_b32 v252, v253, 2, v252
    v_lshlrev_b32 v252, 4, v252
    v_and_b32 v253, 1, v1
    v_lshl_or_b32 v252, v253, 3, v252
    v_lshrrev_b32 v253, 4, v1
    v_lshl_add_u32 v251, v253, 3, v251
    v_lshl_add_u32 v123, v251, 7, v252
    s_branch K_WM2
K_WM1:
    s_cmp_lg_u32 s80, 4
    s_cbranch_scc1 4f
    s_call_b64 s[0:1], K_STB0
4:
    s_cmp_lg_u32 s80, 5
    s_cbranch_scc1 4f
    s_call_b64 s[0:1], K_STB1
4:
    s_cmp_lg_u32 s80, 6
    s_cbranch_scc1 4f
    s_call_b64 s[0:1], K_STB2
4:
    s_cmp_lg_u32 s80, 7
    s_cbranch_scc1 4f
    s_call_b64 s[0:1], K_STB3
4:
K_WM2:
    v_and_b32 v253, 7, v0
    v_lshlrev_b32 v56, 4, v253
    v_sub_u32 v58, 0, v56
    v_ashrrev_i32 v59, 1, v58
    v_lshrrev_b32 v252, 3, v0
    v_mul_u32_u24 v57, 51200, v252
    v_add3_u32 v57, v57, s81, v56
    v_and_b32 v254, 3, v0
    v_lshl_add_u32 v252, v252, 2, v254
    v_lshlrev_b32 v60, 11, v252
    v_lshlrev_b32 v61, 10, v252
    v_subrev_u32 v252, s82, v252
    v_cmp_gt_u32 s[50:51], s83, v252
    s_mov_b32 s52, 12800
    s_mov_b32 s53, 25600
    s_mov_b32 s54, 38400
    v_and_b32 v254, 3, v0
    v_lshlrev_b32 v252, 5, v254
    v_and_b32 v253, 4, v0
    v_lshl_add_u32 v252, v253, 8, v252
    v_and_b32 v253, 56, v0
    v_lshl_add_u32 v252, v253, 4, v252
    s_lshl_b32 s92, s80, 29
    v_lshl_add_u32 v220, v252, 16, s92
    v_add_u32 v221, 0x80000, v220
    v_add_u32 v222, 0x100000, v220
    v_add_u32 v223, 0x180000, v220
    v_add_u32 v224, 0x8000000, v220
    v_add_u32 v225, 0x8080000, v220
    v_add_u32 v226, 0x8100000, v220
    v_add_u32 v227, 0x8180000, v220
    v_add_u32 v228, 0x10000000, v220
    v_add_u32 v229, 0x10080000, v220
    v_add_u32 v230, 0x10100000, v220
    v_add_u32 v231, 0x10180000, v220
    v_add_u32 v196, 0x18000000, v220
    v_add_u32 v197, 0x18080000, v220
    v_add_u32 v198, 0x18100000, v220
    v_add_u32 v199, 0x18180000, v220
    s_lshl_b32 s92, s2, 2
    s_add_u32 s92, s92, 13369344
    s_add_u32 s44, s14, s92
    s_addc_u32 s45, s15, 0
    s_mov_b32 s46, 262144
    s_mov_b32 s47, 0x00020000
    v_mov_b32 v62, s89
    s_mov_b32 s94, 0xc003c003
    s_mov_b32 s93, 0
    s_mov_b32 exec_lo, 0x0f0f0f0f
    s_mov_b32 exec_hi, 0x0f0f0f0f
K_POLL:
    buffer_load_dwordx2 v[8:9], v60, s[16:19], 0 offen sc1
    s_add_u32 s93, s93, 1
    s_cmp_gt_u32 s93, 4194304
    s_cbranch_scc1 K_END
    s_waitcnt vmcnt(0)
K_PCHK:
    v_xor_b32 v252, s89, v9
    v_and_or_b32 v252, v8, s94, v252
    v_cmp_ne_u32 vcc, 0, v252
    s_cbranch_vccz K_AOK
    s_mov_b64 exec, vcc
    s_branch K_POLL
K_AOK:
    s_mov_b64 exec, -1
    v_mov_b32_dpp v8, v8 row_shr:4 row_mask:0xf bank_mask:0xa
    v_lshrrev_b32 v9, 16, v8
    v_and_b32 v8, 0xffff, v8
    v_subrev_u32 v249, s81, v9
    v_cndmask_b32 v9, 0, v249, s[50:51]
    v_add_u32_dpp v76, v8, v57 quad_perm:[0,0,0,0] row_mask:0xf bank_mask:0xf
    v_add_u32_dpp v77, v8, v57 quad_perm:[1,1,1,1] row_mask:0xf bank_mask:0xf
    v_add_u32_dpp v78, v8, v57 quad_perm:[2,2,2,2] row_mask:0xf bank_mask:0xf
    v_add_u32_dpp v79, v8, v57 quad_perm:[3,3,3,3] row_mask:0xf bank_mask:0xf
    v_add_u32_dpp v84, v9, v58 quad_perm:[0,0,0,0] row_mask:0xf bank_mask:0xf
    v_add_u32_dpp v85, v9, v58 quad_perm:[1,1,1,1] row_mask:0xf bank_mask:0xf
    v_add_u32_dpp v86, v9, v58 quad_perm:[2,2,2,2] row_mask:0xf bank_mask:0xf
    v_add_u32_dpp v87, v9, v58 quad_perm:[3,3,3,3] row_mask:0xf bank_mask:0xf
    v_cmp_lt_i32 s[48:49], 0, v84
    v_cmp_lt_i32 s[56:57], 0, v85
    v_cmp_lt_i32 s[64:65], 0, v86
    v_cmp_lt_i32 s[72:73], 0, v87
    s_mov_b64 exec, s[48:49]
    buffer_load_dwordx4 v[20:23], v76, s[20:23], 0 offen sc1
    s_mov_b64 exec, s[56:57]
    buffer_load_dwordx4 v[24:27], v77, s[20:23], s52 offen sc1
    s_mov_b64 exec, s[64:65]
    buffer_load_dwordx4 v[28:31], v78, s[20:23], s53 offen sc1
    s_mov_b64 exec, s[72:73]
    buffer_load_dwordx4 v[32:35], v79, s[20:23], s54 offen sc1
    s_mov_b64 exec, -1
    v_add_u32_dpp v88, v9, v59 quad_perm:[0,0,0,0] row_mask:0xf bank_mask:0xf
    v_lshl_add_u32 v80, v76, 1, v58
    v_cmp_lt_i32 s[50:51], 4, v84
    v_cmp_lt_i32 s[52:53], 8, v84
    v_cmp_lt_i32 s[54:55], 12, v84
    v_add_u32_dpp v89, v9, v59 quad_perm:[1,1,1,1] row_mask:0xf bank_mask:0xf
    v_lshl_add_u32 v81, v77, 1, v58
    v_cmp_lt_i32 s[58:59], 4, v85
    v_cmp_lt_i32 s[60:61], 8, v85
    v_cmp_lt_i32 s[62:63], 12, v85
    v_add_u32_dpp v90, v9, v59 quad_perm:[2,2,2,2] row_mask:0xf bank_mask:0xf
    v_lshl_add_u32 v82, v78, 1, v58
    v_cmp_lt_i32 s[66:67], 4, v86
    v_cmp_lt_i32 s[68:69], 8, v86
    v_cmp_lt_i32 s[70:71], 12, v86
    v_add_u32_dpp v91, v9, v59 quad_perm:[3,3,3,3] row_mask:0xf bank_mask:0xf
    v_lshl_add_u32 v83, v79, 1, v58
    v_cmp_lt_i32 s[74:75], 4, v87
    v_cmp_lt_i32 s[76:77], 8, v87
    v_cmp_lt_i32 s[78:79], 12, v87
    v_cmp_lt_i32 vcc, 0x80, v249
    s_mov_b32 s95, 0
    s_cbranch_vccnz K_MORE
K_NOMORE:
    v_mov_b32 v251, 4
    v_mov_b32 v63, 0xfc
    s_movk_i32 s94, 0x3fff
    s_mov_b32 s3, 0
    s_and_b32 s92, s2, 31
    s_lshl_b32 s93, s80, 5
    s_add_u32 s92, s92, s93
    s_mul_i32 s92, s92, 49
    v_add_u32 v250, s92, v1
    s_branch K_CUT2
.p2align 12
K_CUT2:
    s_waitcnt vmcnt(3)
    s_mov_b64 exec, s[48:49]
    v_and_b32_sdwa v40, v63, v20 dst_sel:DWORD dst_unused:UNUSED_PAD src0_sel:DWORD src1_sel:BYTE_3
    ds_add_rtn_u32 v40, v40, v251 offset:0
    s_mov_b64 exec, s[50:51]
    v_and_b32_sdwa v41, v63, v21 dst_sel:DWORD dst_unused:UNUSED_PAD src0_sel:DWORD src1_sel:BYTE_3
    ds_add_rtn_u32 v41, v41, v251 offset:0
    s_mov_b64 exec, s[52:53]
    v_and_b32_sdwa v42, v63, v22 dst_sel:DWORD dst_unused:UNUSED_PAD src0_sel:DWORD src1_sel:BYTE_3
    ds_add_rtn_u32 v42, v42, v251 offset:0
    s_mov_b64 exec, s[54:55]
    v_and_b32_sdwa v43, v63, v23 dst_sel:DWORD dst_unused:UNUSED_PAD src0_sel:DWORD src1_sel:BYTE_3
    ds_add_rtn_u32 v43, v43, v251 offset:0
    s_waitcnt vmcnt(2)
    s_mov_b64 exec, s[56:57]
    v_and_b32_sdwa v44, v63, v24 dst_sel:DWORD dst_unused:UNUSED_PAD src0_sel:DWORD src1_sel:BYTE_3
    ds_add_rtn_u32 v44, v44, v251 offset:0
    s_mov_b64 exec, s[58:59]
    v_and_b32_sdwa v45, v63, v25 dst_sel:DWORD dst_unused:UNUSED_PAD src0_sel:DWORD src1_sel:BYTE_3
    ds_add_rtn_u32 v45, v45, v251 offset:0
    s_mov_b64 exec, s[60:61]
    v_and_b32_sdwa v46, v63, v26 dst_sel:DWORD dst_unused:UNUSED_PAD src0_sel:DWORD src1_sel:BYTE_3
    ds_add_rtn_u32 v46, v46, v251 offset:0
    s_mov_b64 exec, s[62:63]
    v_and_b32_sdwa v47, v63, v27 dst_sel:DWORD dst_unused:UNUSED_PAD src0_sel:DWORD src1_sel:BYTE_3
    ds_add_rtn_u32 v47, v47, v251 offset:0
    s_waitcnt vmcnt(1)
    s_mov_b32 exec_lo, 0x0f0f0f0f
    s_mov_b32 exec_hi, 0x0f0f0f0f
    buffer_load_dword v62, v61, s[44:47], 0 offen sc1
    s_mov_b64 exec, -1
    s_mov_b64 exec, s[64:65]
    v_and_b32_sdwa v48, v63, v28 dst_sel:DWORD dst_unused:UNUSED_PAD src0_sel:DWORD src1_sel:BYTE_3
    ds_add_rtn_u32 v48, v48, v251 offset:0
    s_mov_b64 exec, s[66:67]
    v_and_b32_sdwa v49, v63, v29 dst_sel:DWORD dst_unused:UNUSED_PAD src0_sel:DWORD src1_sel:BYTE_3
    ds_add_rtn_u32 v49, v49, v251 offset:0
    s_mov_b64 exec, s[68:69]
    v_and_b32_sdwa v50, v63, v30 dst_sel:DWORD dst_unused:UNUSED_PAD src0_sel:DWORD src1_sel:BYTE_3
    ds_add_rtn_u32 v50, v50, v251 offset:0
    s_mov_b64 exec, s[70:71]
    v_and_b32_sdwa v51, v63, v31 dst_sel:DWORD dst_unused:UNUSED_PAD src0_sel:DWORD src1_sel:BYTE_3
    ds_add_rtn_u32 v51, v51, v251 offset:0
    s_waitcnt vmcnt(1)
    s_mov_b64 exec, s[72:73]
    v_and_b32_sdwa v52, v63, v32 dst_sel:DWORD dst_unused:UNUSED_PAD src0_sel:DWORD src1_sel:BYTE_3
    ds_add_rtn_u32 v52, v52, v251 offset:0
    s_mov_b64 exec, s[74:75]
    v_and_b32_sdwa v53, v63, v33 dst_sel:DWORD dst_unused:UNUSED_PAD src0_sel:DWORD src1_sel:BYTE_3
    ds_add_rtn_u32 v53, v53, v251 offset:0
    s_mov_b64 exec, s[76:77]
    v_and_b32_sdwa v54, v63, v34 dst_sel:DWORD dst_unused:UNUSED_PAD src0_sel:DWORD src1_sel:BYTE_3
    ds_add_rtn_u32 v54, v54, v251 offset:0
    s_mov_b64 exec, s[78:79]
    v_and_b32_sdwa v55, v63, v35 dst_sel:DWORD dst_unused:UNUSED_PAD src0_sel:DWORD src1_sel:BYTE_3
    ds_add_rtn_u32 v55, v55, v251 offset:0
    s_mov_b64 exec, -1
    v_and_or_b32 v20, v20, s94, v220
    v_and_or_b32 v21, v21, s94, v221
    v_and_or_b32 v22, v22, s94, v222
    v_and_or_b32 v23, v23, s94, v223
    v_and_or_b32 v24, v24, s94, v224
    v_and_or_b32 v25, v25, s94, v225
    v_and_or_b32 v26, v26, s94, v226
    v_and_or_b32 v27, v27, s94, v227
    v_and_or_b32 v28, v28, s94, v228
    v_and_or_b32 v29, v29, s94, v229
    v_and_or_b32 v30, v30, s94, v230
    v_and_or_b32 v31, v31, s94, v231
    v_and_or_b32 v32, v32, s94, v196
    v_and_or_b32 v33, v33, s94, v197
    v_and_or_b32 v34, v34, s94, v198
    v_and_or_b32 v35, v35, s94, v199
    s_cmp_ge_u32 s80, 4
    s_cbranch_scc1 K_SB
    s_waitcnt vmcnt(0)
    v_cmp_ne_u32 vcc, s89, v62
    s_cmp_eq_u64 vcc, 0
    s_cselect_b32 s3, 1, 0
    s_cselect_b32 s0, 0, 0x7fffffff
    s_cselect_b32 s1, 64, 0x7fffffff
    s_mov_b32 exec_lo, 0x0
    s_mov_b32 exec_hi, 0x1ffe0
    buffer_load_dword v184, v250, s[28:31], 0 idxen offset:3072 sc1
    s_mov_b64 exec, -1
    s_add_u32 m0, s13, 0
    s_mov_b32 s92, 4096
    v_cmpx_lt_i32 vcc, s0, v88
    s_cbranch_execz 3f
    buffer_load_dwordx4 v80, s[24:27], s92 offen offset:0 sc1 lds
3:
    s_mov_b32 s92, 3200
    v_cmpx_lt_i32 vcc, s1, v88
    s_cbranch_execz 3f
    buffer_load_dwordx4 v80, s[24:27], s92 offen offset:1024 sc1 lds
3:
    s_mov_b64 exec, -1
    s_mov_b32 s92, 27648
    v_cmpx_lt_i32 vcc, s0, v89
    s_cbranch_execz 3f
    buffer_load_dwordx4 v81, s[24:27], s92 offen offset:2048 sc1 lds
3:
    s_mov_b32 s92, 26752
    v_cmpx_lt_i32 vcc, s1, v89
    s_cbranch_execz 3f
    buffer_load_dwordx4 v81, s[24:27], s92 offen offset:3072 sc1 lds
3:
    s_mov_b64 exec, -1
    s_add_u32 m0, s13, 4096
    s_mov_b32 s92, 55296
    v_cmpx_lt_i32 vcc, s0, v90
    s_cbranch_execz 3f
    buffer_load_dwordx4 v82, s[24:27], s92 offen offset:0 sc1 lds
3:
    s_mov_b32 s92, 54400
    v_cmpx_lt_i32 vcc, s1, v90
    s_cbranch_execz 3f
    buffer_load_dwordx4 v82, s[24:27], s92 offen offset:1024 sc1 lds
3:
    s_mov_b64 exec, -1
    s_waitcnt lgkmcnt(0)
    s_barrier
    ds_read_b32 v16, v233 offset:0
    s_mov_b64 exec, s[48:49]
    ds_write_b32 v40, v20
    s_mov_b64 exec, s[50:51]
    ds_write_b32 v41, v21
    s_mov_b64 exec, s[52:53]
    ds_write_b32 v42, v22
    s_mov_b64 exec, s[54:55]
    ds_write_b32 v43, v23
    s_mov_b64 exec, s[56:57]
    ds_write_b32 v44, v24
    s_mov_b64 exec, s[58:59]
    ds_write_b32 v45, v25
    s_mov_b64 exec, -1
    s_waitcnt lgkmcnt(6)
    v_sub_u32 v16, v16, v232
    v_add_u32 v17, 52, v16
    v_add_u32 v252, 56, v16
    v_mul_u32_u24 v17, 4682, v17
    v_mul_u32_u24 v252, 4370, v252
    v_lshrrev_b32 v17, 18, v17
    v_lshrrev_b32 v252, 18, v252
    v_lshl_or_b32 v17, v252, 16, v17
    v_mov_b32 v18, v17
    v_cmp_lt_u32 vcc, 448, v16
    v_lshl_or_b32 v254, v1, 24, v232
    v_add_u32_dpp v18, v18, v18 row_shr:1 row_mask:0xf bank_mask:0xf
    v_mov_b32 v19, 56
    s_add_u32 s94, s80, 4
    v_add_u32_dpp v18, v18, v18 row_shr:2 row_mask:0xf bank_mask:0xf
    s_mov_b64 exec, s[60:61]
    ds_write_b32 v46, v26
    s_mov_b64 exec, -1
    v_add_u32_dpp v18, v18, v18 row_shr:4 row_mask:0xf bank_mask:0xf
    s_mov_b64 exec, s[62:63]
    ds_write_b32 v47, v27
    s_mov_b64 exec, -1
    v_add_u32_dpp v18, v18, v18 row_shr:8 row_mask:0xf bank_mask:0xf
    s_mov_b64 exec, s[64:65]
    ds_write_b32 v48, v28
    s_mov_b64 exec, -1
    v_add_u32_dpp v18, v18, v18 row_bcast:15 row_mask:0xa bank_mask:0xf
    s_mov_b64 exec, s[66:67]
    ds_write_b32 v49, v29
    s_mov_b64 exec, -1
    v_add_u32_dpp v18, v18, v18 row_bcast:31 row_mask:0xc bank_mask:0xf
    s_cbranch_vccnz K_OVF
    v_readlane_b32 s93, v18, 63
    v_sub_u32 v251, v18, v17
    s_and_b32 s92, s93, 0xffff
    s_cmp_gt_u32 s92, 256
    s_cbranch_scc1 K_LONG
    v_and_b32 v17, 0xffff, v17
    v_and_b32 v251, 0xffff, v251
K_PT:
    v_mul_u32_u24 v252, s80, v19
    v_add_lshl_u32 v253, v251, s80, 2
    v_sub_u32 v255, v16, v252
    v_add_u32 v252, v254, v252
    v_min_i32 v255, v255, v19
    v_lshl_or_b32 v252, v255, 14, v252
    v_cmpx_lt_u32 vcc, s80, v17
    ds_write_b32 v253, v252 offset:256
    v_mul_u32_u24 v252, s94, v19
    v_add_lshl_u32 v253, v251, s94, 2
    v_sub_u32 v255, v16, v252
    v_add_u32 v252, v254, v252
    v_min_i32 v255, v255, v19
    v_lshl_or_b32 v252, v255, 14, v252
    v_cmpx_lt_u32 vcc, s94, v17
    ds_write_b32 v253, v252 offset:256
    s_mov_b64 exec, -1
    v_add_u32 v252, v251, v17
    v_lshl_or_b32 v251, v252, 16, v251
K_PT2:
    s_mov_b64 exec, s[68:69]
    ds_write_b32 v50, v30
    s_mov_b64 exec, s[70:71]
    ds_write_b32 v51, v31
    s_mov_b64 exec, s[72:73]
    ds_write_b32 v52, v32
    s_mov_b64 exec, s[74:75]
    ds_write_b32 v53, v33
    s_mov_b64 exec, s[76:77]
    ds_write_b32 v54, v34
    s_mov_b64 exec, s[78:79]
    ds_write_b32 v55, v35
    s_mov_b64 exec, -1
    s_mov_b32 s92, 78848
    v_cmpx_lt_i32 vcc, s0, v91
    s_cbranch_execz 3f
    buffer_load_dwordx4 v83, s[24:27], s92 offen offset:2048 sc1 lds
3:
    s_mov_b32 s92, 77952
    v_cmpx_lt_i32 vcc, s1, v91
    s_cbranch_execz 3f
    buffer_load_dwordx4 v83, s[24:27], s92 offen offset:3072 sc1 lds
3:
    s_mov_b64 exec, -1
    s_branch K_SJ
K_OVF:
    v_mov_b32 v252, 0
    s_mov_b32 exec_lo, 0
    s_mov_b32 exec_hi, 0x80000000
    ds_write_b32 v233, v252 offset:0
    s_mov_b64 exec, -1
    s_branch K_PT2
K_LONG:
    s_lshr_b32 s93, s93, 16
    s_cmp_gt_u32 s93, 256
    s_cbranch_scc1 K_OVF
    v_and_b32 v252, 0xffff, v251
    v_cmp_le_u32 vcc, 128, v252
    v_lshrrev_b32 v251, 16, v251
    s_ff1_i32_b64 s92, vcc
    v_sub_u32 v253, v252, v251
    s_nop 0
    v_readlane_b32 s92, v253, s92
    s_nop 0
    s_add_u32 s93, s93, s92
    s_cmp_gt_u32 s93, 256
    s_cselect_b32 s92, 0, s92
    s_cselect_b64 vcc, -1, vcc
    v_add_u32 v251, s92, v251
    v_lshrrev_b32 v253, 16, v17
    v_and_b32 v17, 0xffff, v17
    v_cndmask_b32_e64 v251, v252, v251, vcc
    v_cndmask_b32_e64 v17, v17, v253, vcc
    v_cndmask_b32_e64 v19, 56, 60, vcc
    s_branch K_PT
K_SB:
    s_waitcnt lgkmcnt(0)
    s_barrier
    s_mov_b64 exec, s[48:49]
    ds_write_b32 v40, v20
    s_mov_b64 exec, s[50:51]
    ds_write_b32 v41, v21
    s_mov_b64 exec, s[52:53]
    ds_write_b32 v42, v22
    s_mov_b64 exec, s[54:55]
    ds_write_b32 v43, v23
    s_mov_b64 exec, -1
    s_waitcnt vmcnt(0)
    v_cmp_ne_u32 vcc, s89, v62
    s_cmp_eq_u64 vcc, 0
    s_cselect_b32 s3, 1, 0
    s_cselect_b32 s0, 0, 0x7fffffff
    s_cselect_b32 s1, 64, 0x7fffffff
    s_add_u32 m0, s13, 0
    s_mov_b32 s92, 4096
    v_cmpx_lt_i32 vcc, s0, v88
    s_cbranch_execz 3f
    buffer_load_dwordx4 v80, s[24:27], s92 offen offset:0 sc1 lds
3:
    s_mov_b64 exec, s[56:57]
    ds_write_b32 v44, v24
    s_mov_b64 exec, s[58:59]
    ds_write_b32 v45, v25
    s_mov_b64 exec, -1
    s_mov_b32 s92, 3200
    v_cmpx_lt_i32 vcc, s1, v88
    s_cbranch_execz 3f
    buffer_load_dwordx4 v80, s[24:27], s92 offen offset:1024 sc1 lds
3:
    s_mov_b64 exec, s[60:61]
    ds_write_b32 v46, v26
    s_mov_b64 exec, s[62:63]
    ds_write_b32 v47, v27
    s_mov_b64 exec, -1
    s_mov_b32 s92, 27648
    v_cmpx_lt_i32 vcc, s0, v89
    s_cbranch_execz 3f
    buffer_load_dwordx4 v81, s[24:27], s92 offen offset:2048 sc1 lds
3:
    s_mov_b64 exec, s[64:65]
    ds_write_b32 v48, v28
    s_mov_b64 exec, s[66:67]
    ds_write_b32 v49, v29
    s_mov_b64 exec, -1
    s_mov_b32 s92, 26752
    v_cmpx_lt_i32 vcc, s1, v89
    s_cbranch_execz 3f
    buffer_load_dwordx4 v81, s[24:27], s92 offen offset:3072 sc1 lds
3:
    s_mov_b64 exec, s[68:69]
    ds_write_b32 v50, v30
    s_mov_b64 exec, s[70:71]
    ds_write_b32 v51, v31
    s_mov_b64 exec, -1
    s_add_u32 m0, s13, 4096
    s_mov_b32 s92, 55296
    v_cmpx_lt_i32 vcc, s0, v90
    s_cbranch_execz 3f
    buffer_load_dwordx4 v82, s[24:27], s92 offen offset:0 sc1 lds
3:
    s_mov_b64 exec, s[72:73]
    ds_write_b32 v52, v32
    s_mov_b64 exec, s[74:75]
    ds_write_b32 v53, v33
    s_mov_b64 exec, -1
    s_mov_b32 s92, 54400
    v_cmpx_lt_i32 vcc, s1, v90
    s_cbranch_execz 3f
    buffer_load_dwordx4 v82, s[24:27], s92 offen offset:1024 sc1 lds
3:
    s_mov_b64 exec, s[76:77]
    ds_write_b32 v54, v34
    s_mov_b64 exec, s[78:79]
    ds_write_b32 v55, v35
    s_mov_b64 exec, -1
    s_mov_b32 s92, 78848
    v_cmpx_lt_i32 vcc, s0, v91
    s_cbranch_execz 3f
    buffer_load_dwordx4 v83, s[24:27], s92 offen offset:2048 sc1 lds
3:
    s_mov_b32 s92, 77952
    v_cmpx_lt_i32 vcc, s1, v91
    s_cbranch_execz 3f
    buffer_load_dwordx4 v83, s[24:27], s92 offen offset:3072 sc1 lds
3:
    s_mov_b64 exec, -1
K_SJ:
    s_cmp_lg_u32 s3, 0
    s_cbranch_scc1 K_BY
    s_mov_b32 exec_lo, 0x0f0f0f0f
    s_mov_b32 exec_hi, 0x0f0f0f0f
    buffer_load_dword v62, v61, s[44:47], 0 offen sc1
    s_mov_b64 exec, -1
K_BY:
    s_waitcnt lgkmcnt(0)
    s_barrier
    ds_read_b128 v[196:199], v235 offset:256
    ds_read_b32 v255, v234 offset:256
    v_lshrrev_b32 v253, 5, v247
    v_and_b32 v253, 0xfc, v253
    v_and_b32 v252, 32, v1
    v_lshrrev_b32 v252, 1, v252
    v_add_u32 v252, 122880, v252
    s_waitcnt lgkmcnt(1)
    v_and_b32 v196, 0xffff, v196
    ds_read_u16 v188, v196
    v_and_b32 v197, 0xffff, v197
    ds_read_u16 v190, v197
    v_and_b32 v198, 0xffff, v198
    ds_read_u16 v192, v198
    v_and_b32 v199, 0xffff, v199
    ds_read_u16 v194, v199
    s_movk_i32 s92, 272
    s_mov_b32 m0, s86
    s_waitcnt lgkmcnt(4)
    v_lshrrev_b32 v254, 24, v255
    v_mad_u32_u24 v252, v254, s92, v252
    v_and_b32 v236, 0xffff, v255
    v_bfe_u32 v249, v255, 16, 8
    s_waitcnt lgkmcnt(0)
    buffer_load_dwordx4 v[188:189], s[28:31], 0 idxen offen offset:0 sc1 lds
    buffer_load_dwordx4 v[190:191], s[28:31], 0 idxen offen offset:1024 sc1 lds
    buffer_load_dwordx4 v[192:193], s[28:31], 0 idxen offen offset:2048 sc1 lds
    buffer_load_dwordx4 v[194:195], s[28:31], 0 idxen offen offset:3072 sc1 lds
    ds_read_b128 v[124:127], v252 offset:0
    ds_read_b128 v[128:131], v252 offset:32
    ds_read_b128 v[132:135], v252 offset:64
    ds_read_b128 v[136:139], v252 offset:96
    ds_read_b128 v[140:143], v252 offset:128
    ds_read_b128 v[144:147], v252 offset:160
    ds_read_b128 v[148:151], v252 offset:192
    ds_read_b128 v[152:155], v252 offset:224
    ds_read_u16 v188, v196 offset:4
    ds_read_u16 v190, v197 offset:4
    ds_read_u16 v192, v198 offset:4
    ds_read_u16 v194, v199 offset:4
    ds_read_u16 v237, v236 offset:2
    ds_bpermute_b32 v248, v253, v251
    ds_read_b32 v16, v233 offset:0
    s_cmp_lg_u32 s3, 0
    s_cbranch_scc1 K_BDONE
    s_mov_b32 s94, 0
    s_waitcnt vmcnt(4)
    s_branch K_PBC
K_PB:
    s_mov_b32 exec_lo, 0x0f0f0f0f
    s_mov_b32 exec_hi, 0x0f0f0f0f
    buffer_load_dword v62, v61, s[44:47], 0 offen sc1
    s_mov_b64 exec, -1
    s_add_u32 s94, s94, 1
    s_cmp_gt_u32 s94, 4194304
    s_cbranch_scc1 K_END
    s_waitcnt vmcnt(0)
K_PBC:
    v_cmp_ne_u32 vcc, s89, v62
    s_cbranch_vccnz K_PB
    s_add_u32 m0, s13, 0
    s_mov_b32 s92, 4096
    v_cmpx_lt_i32 vcc, 0, v88
    s_cbranch_execz 3f
    buffer_load_dwordx4 v80, s[24:27], s92 offen offset:0 sc1 lds
3:
    s_mov_b32 s92, 3200
    v_cmpx_lt_i32 vcc, 64, v88
    s_cbranch_execz 3f
    buffer_load_dwordx4 v80, s[24:27], s92 offen offset:1024 sc1 lds
3:
    s_mov_b64 exec, -1
    s_mov_b32 s92, 27648
    v_cmpx_lt_i32 vcc, 0, v89
    s_cbranch_execz 3f
    buffer_load_dwordx4 v81, s[24:27], s92 offen offset:2048 sc1 lds
3:
    s_mov_b32 s92, 26752
    v_cmpx_lt_i32 vcc, 64, v89
    s_cbranch_execz 3f
    buffer_load_dwordx4 v81, s[24:27], s92 offen offset:3072 sc1 lds
3:
    s_mov_b64 exec, -1
    s_add_u32 m0, s13, 4096
    s_mov_b32 s92, 55296
    v_cmpx_lt_i32 vcc, 0, v90
    s_cbranch_execz 3f
    buffer_load_dwordx4 v82, s[24:27], s92 offen offset:0 sc1 lds
3:
    s_mov_b32 s92, 54400
    v_cmpx_lt_i32 vcc, 64, v90
    s_cbranch_execz 3f
    buffer_load_dwordx4 v82, s[24:27], s92 offen offset:1024 sc1 lds
3:
    s_mov_b64 exec, -1
    s_mov_b32 s92, 78848
    v_cmpx_lt_i32 vcc, 0, v91
    s_cbranch_execz 3f
    buffer_load_dwordx4 v83, s[24:27], s92 offen offset:2048 sc1 lds
3:
    s_mov_b32 s92, 77952
    v_cmpx_lt_i32 vcc, 64, v91
    s_cbranch_execz 3f
    buffer_load_dwordx4 v83, s[24:27], s92 offen offset:3072 sc1 lds
3:
    s_mov_b64 exec, -1
K_BDONE:
    s_cmp_lg_u32 s95, 0
    s_cbranch_scc1 K_XE
K_XED:
    v_cmp_lt_u32 s[50:51], 1, v249
    v_cmp_lt_u32 s[52:53], 2, v249
    v_cmp_lt_u32 s[54:55], 3, v249
    v_cmp_lt_u32 s[56:57], 4, v249
    v_cmp_lt_u32 s[58:59], 5, v249
    v_cmp_lt_u32 s[60:61], 6, v249
    v_cmp_lt_u32 s[62:63], 7, v249
    v_cmp_lt_u32 s[64:65], 8, v249
    v_cmp_lt_u32 s[66:67], 9, v249
    v_cmp_lt_u32 s[68:69], 10, v249
    v_cmp_lt_u32 s[70:71], 11, v249
    v_cmp_lt_u32 s[72:73], 12, v249
    v_cmp_lt_u32 s[74:75], 13, v249
    v_cmp_lt_u32 s[76:77], 14, v249
    s_waitcnt lgkmcnt(0)
    v_cmp_eq_u32 vcc, 0, v16
    s_barrier
    s_cbranch_vccnz K_RETRY
    s_add_u32 m0, s86, 32768
    s_nop 0
    buffer_load_dwordx4 v[188:189], s[28:31], 0 idxen offen offset:0 sc1 lds
    buffer_load_dwordx4 v[190:191], s[28:31], 0 idxen offen offset:1024 sc1 lds
    buffer_load_dwordx4 v[192:193], s[28:31], 0 idxen offen offset:2048 sc1 lds
    buffer_load_dwordx4 v[194:195], s[28:31], 0 idxen offen offset:3072 sc1 lds
    ds_read_u16 v188, v196 offset:8
    ds_read_u16 v190, v197 offset:8
    ds_read_u16 v192, v198 offset:8
    ds_read_u16 v194, v199 offset:8
    v_mov_b32 v250, 0
    s_cmp_ge_u32 s80, 4
    s_cbranch_scc1 K_NOTC
    v_cndmask_b32 v248, 0, v248, s[90:91]
    s_nop 0
    v_readfirstlane_b32 s87, v248
    v_readlane_b32 s92, v248, 11
    v_readlane_b32 s93, v248, 12
    s_bfe_u32 s87, s87, 0xc0004
    s_min_u32 s87, s87, 10
    s_max_u32 s88, s92, s93
    s_lshr_b32 s88, s88, 16
    v_lshrrev_b32 v251, 1, v1
    s_lshl_b32 s92, s87, 4
    v_and_b32 v251, 24, v251
    v_add_u32 v251, s92, v251
    v_and_b32 v252, 0xffff, v248
    v_lshrrev_b32 v253, 16, v248
    v_sub_u32 v252, v252, v251
    v_sub_u32 v253, v253, v251
    v_med3_i32 v254, v252, 0, 8
    v_med3_i32 v255, v253, 0, 8
    v_mad_u32_u24 v254, v254, 9, v255
    v_lshlrev_b32 v254, 4, v254
    ds_read_b128 v[220:223], v254 offset:1280
    v_subrev_u32 v252, 32, v252
    v_subrev_u32 v253, 32, v253
    v_med3_i32 v254, v252, 0, 8
    v_med3_i32 v255, v253, 0, 8
    v_mad_u32_u24 v254, v254, 9, v255
    v_lshlrev_b32 v254, 4, v254
    ds_read_b128 v[224:227], v254 offset:1280
    v_subrev_u32 v252, 32, v252
    v_subrev_u32 v253, 32, v253
    v_med3_i32 v254, v252, 0, 8
    v_med3_i32 v255, v253, 0, 8
    v_mad_u32_u24 v254, v254, 9, v255
    v_lshlrev_b32 v254, 4, v254
    ds_read_b128 v[228:231], v254 offset:1280
    s_lshl_b32 s92, s87, 11
    s_add_u32 s92, s92, 90112
    v_add_u32 v242, s92, v123
    v_xor_b32 v243, 32, v242
    v_xor_b32 v244, 64, v242
    v_xor_b32 v245, 96, v242
K_NOTC:
    s_waitcnt vmcnt(4)
    ds_read_b128 v[156:159], v200 offset:0
    ds_read_b128 v[160:163], v201 offset:0
    ds_read_b128 v[164:167], v202 offset:0
    ds_read_b128 v[168:171], v203 offset:0
    s_barrier
    ds_read_b64 v[184:185], v237 offset:24576
    ds_read_u16 v237, v236 offset:6
    s_cmp_lg_u32 s84, 0
    s_cbranch_scc1 K_SAFE
    s_cmp_ge_u32 s80, 4
    s_waitcnt lgkmcnt(1)
    v_mfma_f32_32x32x8_bf16 v[4:19], v[180:181], v[184:185], v[124:139]
    v_smfmac_f32_32x32x32_bf16 v[4:19], v[172:175], v[156:163], v176
    s_nop 0
    s_cbranch_scc1 K_MAINB
    s_branch K_MAINA
.p2align 12
K_STA0:
    s_setpc_b64 s[0:1]
K_MAINA:
    s_waitcnt lgkmcnt(0)
    s_mov_b32 m0, s86
    ds_read_b64 v[186:187], v237 offset:24576
    buffer_load_dwordx4 v[188:189], s[28:31], 0 idxen offen offset:0 sc1 lds
    buffer_load_dwordx4 v[190:191], s[28:31], 0 idxen offen offset:1024 sc1 lds
    buffer_load_dwordx4 v[192:193], s[28:31], 0 idxen offen offset:2048 sc1 lds
    buffer_load_dwordx4 v[194:195], s[28:31], 0 idxen offen offset:3072 sc1 lds
    s_nop 2
    s_setprio 2
    v_exp_f32 v72, v4
    v_exp_f32 v73, v5
    v_exp_f32 v74, v6
    v_mfma_f32_32x32x8_bf16 v[20:35], v[182:183], v[184:185], v[140:155]
    v_exp_f32 v75, v7
    v_exp_f32 v76, v8
    v_exp_f32 v77, v9
    v_exp_f32 v78, v10
    v_exp_f32 v79, v11
    v_smfmac_f32_32x32x32_bf16 v[20:35], v[172:175], v[164:171], v176
    v_exp_f32 v80, v12
    v_exp_f32 v81, v13
    v_exp_f32 v82, v14
    v_exp_f32 v83, v15
    v_exp_f32 v84, v16
    v_exp_f32 v85, v17
    v_exp_f32 v86, v18
    v_exp_f32 v87, v19
    s_setprio 0
    s_waitcnt vmcnt(4)
    ds_read_b128 v[156:159], v200 offset:32768
    ds_read_b128 v[160:163], v201 offset:32768
    ds_read_b128 v[164:167], v202 offset:32768
    ds_read_b128 v[168:171], v203 offset:32768
    ds_read_u16 v188, v196 offset:12
    ds_read_u16 v190, v197 offset:12
    ds_read_u16 v192, v198 offset:12
    ds_read_u16 v194, v199 offset:12
    ds_read_u16 v237, v236 offset:10
    s_waitcnt lgkmcnt(7)
    v_add_f32 v72, 1.0, v72
    v_add_f32 v73, 1.0, v73
    v_add_f32 v74, 1.0, v74
    v_add_f32 v75, 1.0, v75
    v_add_f32 v76, 1.0, v76
    v_add_f32 v77, 1.0, v77
    v_add_f32 v78, 1.0, v78
    v_add_f32 v79, 1.0, v79
    v_add_f32 v80, 1.0, v80
    v_add_f32 v81, 1.0, v81
    v_add_f32 v82, 1.0, v82
    v_add_f32 v83, 1.0, v83
    v_add_f32 v84, 1.0, v84
    v_add_f32 v85, 1.0, v85
    v_add_f32 v86, 1.0, v86
    v_add_f32 v87, 1.0, v87
    s_setprio 2
    v_exp_f32 v88, v20
    v_exp_f32 v89, v21
    v_exp_f32 v90, v22
    v_mfma_f32_32x32x8_bf16 v[38:53], v[180:181], v[186:187], v[124:139]
    v_exp_f32 v91, v23
    v_exp_f32 v92, v24
    v_exp_f32 v93, v25
    v_exp_f32 v94, v26
    v_exp_f32 v95, v27
    v_smfmac_f32_32x32x32_bf16 v[38:53], v[172:175], v[156:163], v176
    v_exp_f32 v96, v28
    v_exp_f32 v97, v29
    v_exp_f32 v98, v30
    v_exp_f32 v99, v31
    v_exp_f32 v100, v32
    v_exp_f32 v101, v33
    v_exp_f32 v102, v34
    v_exp_f32 v103, v35
    s_setprio 0
    s_mov_b64 exec, -1
    s_waitcnt vmcnt(0) lgkmcnt(0)
    s_add_u32 m0, s86, 32768
    ds_read_b128 v[156:159], v200 offset:0
    ds_read_b128 v[160:163], v201 offset:0
    ds_read_b64 v[184:185], v237 offset:24576
    buffer_load_dwordx4 v[188:189], s[28:31], 0 idxen offen offset:0 sc1 lds
    buffer_load_dwordx4 v[190:191], s[28:31], 0 idxen offen offset:1024 sc1 lds
    buffer_load_dwordx4 v[192:193], s[28:31], 0 idxen offen offset:2048 sc1 lds
    buffer_load_dwordx4 v[194:195], s[28:31], 0 idxen offen offset:3072 sc1 lds
    v_add_f32 v88, 1.0, v88
    v_add_f32 v89, 1.0, v89
    v_add_f32 v90, 1.0, v90
    v_add_f32 v91, 1.0, v91
    v_add_f32 v92, 1.0, v92
    v_add_f32 v93, 1.0, v93
    v_add_f32 v94, 1.0, v94
    v_add_f32 v95, 1.0, v95
    v_add_f32 v96, 1.0, v96
    v_add_f32 v97, 1.0, v97
    v_add_f32 v98, 1.0, v98
    v_add_f32 v99, 1.0, v99
    v_add_f32 v100, 1.0, v100
    v_add_f32 v101, 1.0, v101
    v_add_f32 v102, 1.0, v102
    v_add_f32 v103, 1.0, v103
    s_setprio 2
    v_exp_f32 v106, v38
    v_exp_f32 v107, v39
    v_exp_f32 v108, v40
    v_mfma_f32_32x32x8_bf16 v[54:69], v[182:183], v[186:187], v[140:155]
    v_exp_f32 v109, v41
    v_exp_f32 v110, v42
    v_exp_f32 v111, v43
    v_exp_f32 v112, v44
    v_exp_f32 v113, v45
    v_smfmac_f32_32x32x32_bf16 v[54:69], v[172:175], v[164:171], v176
    v_exp_f32 v114, v46
    v_exp_f32 v115, v47
    v_exp_f32 v116, v48
    v_exp_f32 v117, v49
    v_exp_f32 v118, v50
    v_exp_f32 v119, v51
    v_exp_f32 v120, v52
    v_exp_f32 v121, v53
    s_setprio 0
    s_mov_b64 exec, -1
    s_waitcnt lgkmcnt(0)
    ds_read_b128 v[164:167], v202 offset:0
    ds_read_b128 v[168:171], v203 offset:0
    ds_read_u16 v188, v196 offset:16
    ds_read_u16 v190, v197 offset:16
    ds_read_u16 v192, v198 offset:16
    ds_read_u16 v194, v199 offset:16
    ds_read_u16 v237, v236 offset:14
    s_mov_b64 exec, s[50:51]
    v_fmac_f32 v4, v4, v106
    v_fmac_f32 v5, v5, v107
    v_fmac_f32 v6, v6, v108
    v_fmac_f32 v7, v7, v109
    v_fmac_f32 v8, v8, v110
    v_fmac_f32 v9, v9, v111
    v_fmac_f32 v10, v10, v112
    v_fmac_f32 v11, v11, v113
    v_fmac_f32 v12, v12, v114
    v_fmac_f32 v13, v13, v115
    v_fmac_f32 v14, v14, v116
    v_fmac_f32 v15, v15, v117
    v_fmac_f32 v16, v16, v118
    v_fmac_f32 v17, v17, v119
    v_fmac_f32 v18, v18, v120
    v_fmac_f32 v19, v19, v121
    v_fmac_f32 v4, v38, v72
    v_fmac_f32 v5, v39, v73
    v_fmac_f32 v6, v40, v74
    v_fmac_f32 v7, v41, v75
    v_fmac_f32 v8, v42, v76
    v_fmac_f32 v9, v43, v77
    v_fmac_f32 v10, v44, v78
    v_fmac_f32 v11, v45, v79
    v_fmac_f32 v12, v46, v80
    v_fmac_f32 v13, v47, v81
    v_fmac_f32 v14, v48, v82
    v_fmac_f32 v15, v49, v83
    v_fmac_f32 v16, v50, v84
    v_fmac_f32 v17, v51, v85
    v_fmac_f32 v18, v52, v86
    v_fmac_f32 v19, v53, v87
    v_fmac_f32 v72, v72, v106
    v_fmac_f32 v73, v73, v107
    v_fmac_f32 v74, v74, v108
    v_fmac_f32 v75, v75, v109
    v_fmac_f32 v76, v76, v110
    v_fmac_f32 v77, v77, v111
    v_fmac_f32 v78, v78, v112
    v_fmac_f32 v79, v79, v113
    v_fmac_f32 v80, v80, v114
    v_fmac_f32 v81, v81, v115
    v_fmac_f32 v82, v82, v116
    v_fmac_f32 v83, v83, v117
    v_fmac_f32 v84, v84, v118
    v_fmac_f32 v85, v85, v119
    v_fmac_f32 v86, v86, v120
    v_fmac_f32 v87, v87, v121
    s_setprio 2
    v_exp_f32 v106, v54
    v_exp_f32 v107, v55
    v_exp_f32 v108, v56
    v_mfma_f32_32x32x8_bf16 v[38:53], v[180:181], v[184:185], v[124:139]
    v_exp_f32 v109, v57
    v_exp_f32 v110, v58
    v_exp_f32 v111, v59
    v_exp_f32 v112, v60
    v_exp_f32 v113, v61
    v_smfmac_f32_32x32x32_bf16 v[38:53], v[172:175], v[156:163], v176
    v_exp_f32 v114, v62
    v_exp_f32 v115, v63
    v_exp_f32 v116, v64
    v_exp_f32 v117, v65
    v_exp_f32 v118, v66
    v_exp_f32 v119, v67
    v_exp_f32 v120, v68
    v_exp_f32 v121, v69
    s_setprio 0
    s_mov_b64 exec, -1
    s_waitcnt vmcnt(0) lgkmcnt(0)
    s_add_u32 m0, s86, 0
    ds_read_b128 v[156:159], v200 offset:32768
    ds_read_b128 v[160:163], v201 offset:32768
    ds_read_b64 v[186:187], v237 offset:24576
    buffer_load_dwordx4 v[188:189], s[28:31], 0 idxen offen offset:0 sc1 lds
    buffer_load_dwordx4 v[190:191], s[28:31], 0 idxen offen offset:1024 sc1 lds
    buffer_load_dwordx4 v[192:193], s[28:31], 0 idxen offen offset:2048 sc1 lds
    buffer_load_dwordx4 v[194:195], s[28:31], 0 idxen offen offset:3072 sc1 lds
    s_mov_b64 exec, s[50:51]
    v_fmac_f32 v20, v20, v106
    v_fmac_f32 v21, v21, v107
    v_fmac_f32 v22, v22, v108
    v_fmac_f32 v23, v23, v109
    v_fmac_f32 v24, v24, v110
    v_fmac_f32 v25, v25, v111
    v_fmac_f32 v26, v26, v112
    v_fmac_f32 v27, v27, v113
    v_fmac_f32 v28, v28, v114
    v_fmac_f32 v29, v29, v115
    v_fmac_f32 v30, v30, v116
    v_fmac_f32 v31, v31, v117
    v_fmac_f32 v32, v32, v118
    v_fmac_f32 v33, v33, v119
    v_fmac_f32 v34, v34, v120
    v_fmac_f32 v35, v35, v121
    v_fmac_f32 v20, v54, v88
    v_fmac_f32 v21, v55, v89
    v_fmac_f32 v22, v56, v90
    v_fmac_f32 v23, v57, v91
    v_fmac_f32 v24, v58, v92
    v_fmac_f32 v25, v59, v93
    v_fmac_f32 v26, v60, v94
    v_fmac_f32 v27, v61, v95
    v_fmac_f32 v28, v62, v96
    v_fmac_f32 v29, v63, v97
    v_fmac_f32 v30, v64, v98
    v_fmac_f32 v31, v65, v99
    v_fmac_f32 v32, v66, v100
    v_fmac_f32 v33, v67, v101
    v_fmac_f32 v34, v68, v102
    v_fmac_f32 v35, v69, v103
    v_fmac_f32 v88, v88, v106
    v_fmac_f32 v89, v89, v107
    v_fmac_f32 v90, v90, v108
    v_fmac_f32 v91, v91, v109
    v_fmac_f32 v92, v92, v110
    v_fmac_f32 v93, v93, v111
    v_fmac_f32 v94, v94, v112
    v_fmac_f32 v95, v95, v113
    v_fmac_f32 v96, v96, v114
    v_fmac_f32 v97, v97, v115
    v_fmac_f32 v98, v98, v116
    v_fmac_f32 v99, v99, v117
    v_fmac_f32 v100, v100, v118
    v_fmac_f32 v101, v101, v119
    v_fmac_f32 v102, v102, v120
    v_fmac_f32 v103, v103, v121
    s_setprio 2
    v_exp_f32 v106, v38
    v_exp_f32 v107, v39
    v_exp_f32 v108, v40
    v_mfma_f32_32x32x8_bf16 v[54:69], v[182:183], v[184:185], v[140:155]
    v_exp_f32 v109, v41
    v_exp_f32 v110, v42
    v_exp_f32 v111, v43
    v_exp_f32 v112, v44
    v_exp_f32 v113, v45
    v_smfmac_f32_32x32x32_bf16 v[54:69], v[172:175], v[164:171], v176
    v_exp_f32 v114, v46
    v_exp_f32 v115, v47
    v_exp_f32 v116, v48
    v_exp_f32 v117, v49
    v_exp_f32 v118, v50
    v_exp_f32 v119, v51
    v_exp_f32 v120, v52
    v_exp_f32 v121, v53
    s_setprio 0
    s_mov_b64 exec, -1
    s_waitcnt lgkmcnt(0)
    ds_read_b128 v[164:167], v202 offset:32768
    ds_read_b128 v[168:171], v203 offset:32768
    ds_read_u16 v188, v196 offset:20
    ds_read_u16 v190, v197 offset:20
    ds_read_u16 v192, v198 offset:20
    ds_read_u16 v194, v199 offset:20
    ds_read_u16 v237, v236 offset:18
    s_mov_b64 exec, s[52:53]
    v_fmac_f32 v4, v4, v106
    v_fmac_f32 v5, v5, v107
    v_fmac_f32 v6, v6, v108
    v_fmac_f32 v7, v7, v109
    v_fmac_f32 v8, v8, v110
    v_fmac_f32 v9, v9, v111
    v_fmac_f32 v10, v10, v112
    v_fmac_f32 v11, v11, v113
    v_fmac_f32 v12, v12, v114
    v_fmac_f32 v13, v13, v115
    v_fmac_f32 v14, v14, v116
    v_fmac_f32 v15, v15, v117
    v_fmac_f32 v16, v16, v118
    v_fmac_f32 v17, v17, v119
    v_fmac_f32 v18, v18, v120
    v_fmac_f32 v19, v19, v121
    v_fmac_f32 v4, v38, v72
    v_fmac_f32 v5, v39, v73
    v_fmac_f32 v6, v40, v74
    v_fmac_f32 v7, v41, v75
    v_fmac_f32 v8, v42, v76
    v_fmac_f32 v9, v43, v77
    v_fmac_f32 v10, v44, v78
    v_fmac_f32 v11, v45, v79
    v_fmac_f32 v12, v46, v80
    v_fmac_f32 v13, v47, v81
    v_fmac_f32 v14, v48, v82
    v_fmac_f32 v15, v49, v83
    v_fmac_f32 v16, v50, v84
    v_fmac_f32 v17, v51, v85
    v_fmac_f32 v18, v52, v86
    v_fmac_f32 v19, v53, v87
    v_fmac_f32 v72, v72, v106
    v_fmac_f32 v73, v73, v107
    v_fmac_f32 v74, v74, v108
    v_fmac_f32 v75, v75, v109
    v_fmac_f32 v76, v76, v110
    v_fmac_f32 v77, v77, v111
    v_fmac_f32 v78, v78, v112
    v_fmac_f32 v79, v79, v113
    v_fmac_f32 v80, v80, v114
    v_fmac_f32 v81, v81, v115
    v_fmac_f32 v82, v82, v116
    v_fmac_f32 v83, v83, v117
    v_fmac_f32 v84, v84, v118
    v_fmac_f32 v85, v85, v119
    v_fmac_f32 v86, v86, v120
    v_fmac_f32 v87, v87, v121
    s_setprio 2
    v_exp_f32 v106, v54
    v_exp_f32 v107, v55
    v_exp_f32 v108, v56
    v_mfma_f32_32x32x8_bf16 v[38:53], v[180:181], v[186:187], v[124:139]
    v_exp_f32 v109, v57
    v_exp_f32 v110, v58
    v_exp_f32 v111, v59
    v_exp_f32 v112, v60
    v_exp_f32 v113, v61
    v_smfmac_f32_32x32x32_bf16 v[38:53], v[172:175], v[156:163], v176
    v_exp_f32 v114, v62
    v_exp_f32 v115, v63
    v_exp_f32 v116, v64
    v_exp_f32 v117, v65
    v_exp_f32 v118, v66
    v_exp_f32 v119, v67
    v_exp_f32 v120, v68
    v_exp_f32 v121, v69
    s_setprio 0
    s_mov_b64 exec, -1
    s_waitcnt vmcnt(0) lgkmcnt(0)
    s_add_u32 m0, s86, 32768
    ds_read_b128 v[156:159], v200 offset:0
    ds_read_b128 v[160:163], v201 offset:0
    ds_read_b64 v[184:185], v237 offset:24576
    buffer_load_dwordx4 v[188:189], s[28:31], 0 idxen offen offset:0 sc1 lds
    buffer_load_dwordx4 v[190:191], s[28:31], 0 idxen offen offset:1024 sc1 lds
    buffer_load_dwordx4 v[192:193], s[28:31], 0 idxen offen offset:2048 sc1 lds
    buffer_load_dwordx4 v[194:195], s[28:31], 0 idxen offen offset:3072 sc1 lds
    s_mov_b64 exec, s[52:53]
    v_fmac_f32 v20, v20, v106
    v_fmac_f32 v21, v21, v107
    v_fmac_f32 v22, v22, v108
    v_fmac_f32 v23, v23, v109
    v_fmac_f32 v24, v24, v110
    v_fmac_f32 v25, v25, v111
    v_fmac_f32 v26, v26, v112
    v_fmac_f32 v27, v27, v113
    v_fmac_f32 v28, v28, v114
    v_fmac_f32 v29, v29, v115
    v_fmac_f32 v30, v30, v116
    v_fmac_f32 v31, v31, v117
    v_fmac_f32 v32, v32, v118
    v_fmac_f32 v33, v33, v119
    v_fmac_f32 v34, v34, v120
    v_fmac_f32 v35, v35, v121
    v_fmac_f32 v20, v54, v88
    v_fmac_f32 v21, v55, v89
    v_fmac_f32 v22, v56, v90
    v_fmac_f32 v23, v57, v91
    v_fmac_f32 v24, v58, v92
    v_fmac_f32 v25, v59, v93
    v_fmac_f32 v26, v60, v94
    v_fmac_f32 v27, v61, v95
    v_fmac_f32 v28, v62, v96
    v_fmac_f32 v29, v63, v97
    v_fmac_f32 v30, v64, v98
    v_fmac_f32 v31, v65, v99
    v_fmac_f32 v32, v66, v100
    v_fmac_f32 v33, v67, v101
    v_fmac_f32 v34, v68, v102
    v_fmac_f32 v35, v69, v103
    v_fmac_f32 v88, v88, v106
    v_fmac_f32 v89, v89, v107
    v_fmac_f32 v90, v90, v108
    v_fmac_f32 v91, v91, v109
    v_fmac_f32 v92, v92, v110
    v_fmac_f32 v93, v93, v111
    v_fmac_f32 v94, v94, v112
    v_fmac_f32 v95, v95, v113
    v_fmac_f32 v96, v96, v114
    v_fmac_f32 v97, v97, v115
    v_fmac_f32 v98, v98, v116
    v_fmac_f32 v99, v99, v117
    v_fmac_f32 v100, v100, v118
    v_fmac_f32 v101, v101, v119
    v_fmac_f32 v102, v102, v120
    v_fmac_f32 v103, v103, v121
    s_setprio 2
    v_exp_f32 v106, v38
    v_exp_f32 v107, v39
    v_exp_f32 v108, v40
    v_mfma_f32_32x32x8_bf16 v[54:69], v[182:183], v[186:187], v[140:155]
    v_exp_f32 v109, v41
    v_exp_f32 v110, v42
    v_exp_f32 v111, v43
    v_exp_f32 v112, v44
    v_exp_f32 v113, v45
    v_smfmac_f32_32x32x32_bf16 v[54:69], v[172:175], v[164:171], v176
    v_exp_f32 v114, v46
    v_exp_f32 v115, v47
    v_exp_f32 v116, v48
    v_exp_f32 v117, v49
    v_exp_f32 v118, v50
    v_exp_f32 v119, v51
    v_exp_f32 v120, v52
    v_exp_f32 v121, v53
    s_setprio 0
    s_mov_b64 exec, -1
    s_waitcnt lgkmcnt(0)
    ds_read_b128 v[164:167], v202 offset:0
    ds_read_b128 v[168:171], v203 offset:0
    ds_read_u16 v188, v196 offset:24
    ds_read_u16 v190, v197 offset:24
    ds_read_u16 v192, v198 offset:24
    ds_read_u16 v194, v199 offset:24
    ds_read_u16 v237, v236 offset:22
    s_mov_b64 exec, s[54:55]
    v_fmac_f32 v4, v4, v106
    v_fmac_f32 v5, v5, v107
    v_fmac_f32 v6, v6, v108
    v_fmac_f32 v7, v7, v109
    v_fmac_f32 v8, v8, v110
    v_fmac_f32 v9, v9, v111
    v_fmac_f32 v10, v10, v112
    v_fmac_f32 v11, v11, v113
    v_fmac_f32 v12, v12, v114
    v_fmac_f32 v13, v13, v115
    v_fmac_f32 v14, v14, v116
    v_fmac_f32 v15, v15, v117
    v_fmac_f32 v16, v16, v118
    v_fmac_f32 v17, v17, v119
    v_fmac_f32 v18, v18, v120
    v_fmac_f32 v19, v19, v121
    v_fmac_f32 v4, v38, v72
    v_fmac_f32 v5, v39, v73
    v_fmac_f32 v6, v40, v74
    v_fmac_f32 v7, v41, v75
    v_fmac_f32 v8, v42, v76
    v_fmac_f32 v9, v43, v77
    v_fmac_f32 v10, v44, v78
    v_fmac_f32 v11, v45, v79
    v_fmac_f32 v12, v46, v80
    v_fmac_f32 v13, v47, v81
    v_fmac_f32 v14, v48, v82
    v_fmac_f32 v15, v49, v83
    v_fmac_f32 v16, v50, v84
    v_fmac_f32 v17, v51, v85
    v_fmac_f32 v18, v52, v86
    v_fmac_f32 v19, v53, v87
    v_fmac_f32 v72, v72, v106
    v_fmac_f32 v73, v73, v107
    v_fmac_f32 v74, v74, v108
    v_fmac_f32 v75, v75, v109
    v_fmac_f32 v76, v76, v110
    v_fmac_f32 v77, v77, v111
    v_fmac_f32 v78, v78, v112
    v_fmac_f32 v79, v79, v113
    v_fmac_f32 v80, v80, v114
    v_fmac_f32 v81, v81, v115
    v_fmac_f32 v82, v82, v116
    v_fmac_f32 v83, v83, v117
    v_fmac_f32 v84, v84, v118
    v_fmac_f32 v85, v85, v119
    v_fmac_f32 v86, v86, v120
    v_fmac_f32 v87, v87, v121
    s_setprio 2
    v_exp_f32 v106, v54
    v_exp_f32 v107, v55
    v_exp_f32 v108, v56
    v_mfma_f32_32x32x8_bf16 v[38:53], v[180:181], v[184:185], v[124:139]
    v_exp_f32 v109, v57
    v_exp_f32 v110, v58
    v_exp_f32 v111, v59
    v_exp_f32 v112, v60
    v_exp_f32 v113, v61
    v_smfmac_f32_32x32x32_bf16 v[38:53], v[172:175], v[156:163], v176
    v_exp_f32 v114, v62
    v_exp_f32 v115, v63
    v_exp_f32 v116, v64
    v_exp_f32 v117, v65
    v_exp_f32 v118, v66
    v_exp_f32 v119, v67
    v_exp_f32 v120, v68
    v_exp_f32 v121, v69
    s_setprio 0
    s_mov_b64 exec, -1
    s_waitcnt vmcnt(0) lgkmcnt(0)
    s_add_u32 m0, s86, 0
    ds_read_b128 v[156:159], v200 offset:32768
    ds_read_b128 v[160:163], v201 offset:32768
    ds_read_b64 v[186:187], v237 offset:24576
    buffer_load_dwordx4 v[188:189], s[28:31], 0 idxen offen offset:0 sc1 lds
    buffer_load_dwordx4 v[190:191], s[28:31], 0 idxen offen offset:1024 sc1 lds
    buffer_load_dwordx4 v[192:193], s[28:31], 0 idxen offen offset:2048 sc1 lds
    buffer_load_dwordx4 v[194:195], s[28:31], 0 idxen offen offset:3072 sc1 lds
    s_mov_b64 exec, s[54:55]
    v_fmac_f32 v20, v20, v106
    v_fmac_f32 v21, v21, v107
    v_fmac_f32 v22, v22, v108
    v_fmac_f32 v23, v23, v109
    v_fmac_f32 v24, v24, v110
    v_fmac_f32 v25, v25, v111
    v_fmac_f32 v26, v26, v112
    v_fmac_f32 v27, v27, v113
    v_fmac_f32 v28, v28, v114
    v_fmac_f32 v29, v29, v115
    v_fmac_f32 v30, v30, v116
    v_fmac_f32 v31, v31, v117
    v_fmac_f32 v32, v32, v118
    v_fmac_f32 v33, v33, v119
    v_fmac_f32 v34, v34, v120
    v_fmac_f32 v35, v35, v121
    v_fmac_f32 v20, v54, v88
    v_fmac_f32 v21, v55, v89
    v_fmac_f32 v22, v56, v90
    v_fmac_f32 v23, v57, v91
    v_fmac_f32 v24, v58, v92
    v_fmac_f32 v25, v59, v93
    v_fmac_f32 v26, v60, v94
    v_fmac_f32 v27, v61, v95
    v_fmac_f32 v28, v62, v96
    v_fmac_f32 v29, v63, v97
    v_fmac_f32 v30, v64, v98
    v_fmac_f32 v31, v65, v99
    v_fmac_f32 v32, v66, v100
    v_fmac_f32 v33, v67, v101
    v_fmac_f32 v34, v68, v102
    v_fmac_f32 v35, v69, v103
    v_fmac_f32 v88, v88, v106
    v_fmac_f32 v89, v89, v107
    v_fmac_f32 v90, v90, v108
    v_fmac_f32 v91, v91, v109
    v_fmac_f32 v92, v92, v110
    v_fmac_f32 v93, v93, v111
    v_fmac_f32 v94, v94, v112
    v_fmac_f32 v95, v95, v113
    v_fmac_f32 v96, v96, v114
    v_fmac_f32 v97, v97, v115
    v_fmac_f32 v98, v98, v116
    v_fmac_f32 v99, v99, v117
    v_fmac_f32 v100, v100, v118
    v_fmac_f32 v101, v101, v119
    v_fmac_f32 v102, v102, v120
    v_fmac_f32 v103, v103, v121
    s_setprio 2
    v_exp_f32 v106, v38
    v_exp_f32 v107, v39
    v_exp_f32 v108, v40
    v_mfma_f32_32x32x8_bf16 v[54:69], v[182:183], v[184:185], v[140:155]
    v_exp_f32 v109, v41
    v_exp_f32 v110, v42
    v_exp_f32 v111, v43
    v_exp_f32 v112, v44
    v_exp_f32 v113, v45
    v_smfmac_f32_32x32x32_bf16 v[54:69], v[172:175], v[164:171], v176
    v_exp_f32 v114, v46
    v_exp_f32 v115, v47
    v_exp_f32 v116, v48
    v_exp_f32 v117, v49
    v_exp_f32 v118, v50
    v_exp_f32 v119, v51
    v_exp_f32 v120, v52
    v_exp_f32 v121, v53
    s_setprio 0
    s_mov_b64 exec, -1
    s_waitcnt lgkmcnt(0)
    ds_read_b128 v[164:167], v202 offset:32768
    ds_read_b128 v[168:171], v203 offset:32768
    ds_read_u16 v188, v196 offset:28
    ds_read_u16 v190, v197 offset:28
    ds_read_u16 v192, v198 offset:28
    ds_read_u16 v194, v199 offset:28
    ds_read_u16 v237, v236 offset:26
    s_mov_b64 exec, s[56:57]
    v_fmac_f32 v4, v4, v106
    v_fmac_f32 v5, v5, v107
    v_fmac_f32 v6, v6, v108
    v_fmac_f32 v7, v7, v109
    v_fmac_f32 v8, v8, v110
    v_fmac_f32 v9, v9, v111
    v_fmac_f32 v10, v10, v112
    v_fmac_f32 v11, v11, v113
    v_fmac_f32 v12, v12, v114
    v_fmac_f32 v13, v13, v115
    v_fmac_f32 v14, v14, v116
    v_fmac_f32 v15, v15, v117
    v_fmac_f32 v16, v16, v118
    v_fmac_f32 v17, v17, v119
    v_fmac_f32 v18, v18, v120
    v_fmac_f32 v19, v19, v121
    v_fmac_f32 v4, v38, v72
    v_fmac_f32 v5, v39, v73
    v_fmac_f32 v6, v40, v74
    v_fmac_f32 v7, v41, v75
    v_fmac_f32 v8, v42, v76
    v_fmac_f32 v9, v43, v77
    v_fmac_f32 v10, v44, v78
    v_fmac_f32 v11, v45, v79
    v_fmac_f32 v12, v46, v80
    v_fmac_f32 v13, v47, v81
    v_fmac_f32 v14, v48, v82
    v_fmac_f32 v15, v49, v83
    v_fmac_f32 v16, v50, v84
    v_fmac_f32 v17, v51, v85
    v_fmac_f32 v18, v52, v86
    v_fmac_f32 v19, v53, v87
    v_fmac_f32 v72, v72, v106
    v_fmac_f32 v73, v73, v107
    v_fmac_f32 v74, v74, v108
    v_fmac_f32 v75, v75, v109
    v_fmac_f32 v76, v76, v110
    v_fmac_f32 v77, v77, v111
    v_fmac_f32 v78, v78, v112
    v_fmac_f32 v79, v79, v113
    v_fmac_f32 v80, v80, v114
    v_fmac_f32 v81, v81, v115
    v_fmac_f32 v82, v82, v116
    v_fmac_f32 v83, v83, v117
    v_fmac_f32 v84, v84, v118
    v_fmac_f32 v85, v85, v119
    v_fmac_f32 v86, v86, v120
    v_fmac_f32 v87, v87, v121
    s_setprio 2
    v_exp_f32 v106, v54
    v_exp_f32 v107, v55
    v_exp_f32 v108, v56
    v_mfma_f32_32x32x8_bf16 v[38:53], v[180:181], v[186:187], v[124:139]
    v_exp_f32 v109, v57
    v_exp_f32 v110, v58
    v_exp_f32 v111, v59
    v_exp_f32 v112, v60
    v_exp_f32 v113, v61
    v_smfmac_f32_32x32x32_bf16 v[38:53], v[172:175], v[156:163], v176
    v_exp_f32 v114, v62
    v_exp_f32 v115, v63
    v_exp_f32 v116, v64
    v_exp_f32 v117, v65
    v_exp_f32 v118, v66
    v_exp_f32 v119, v67
    v_exp_f32 v120, v68
    v_exp_f32 v121, v69
    s_setprio 0
    s_mov_b64 exec, -1
    s_waitcnt vmcnt(0) lgkmcnt(0)
    s_add_u32 m0, s86, 32768
    ds_read_b128 v[156:159], v200 offset:0
    ds_read_b128 v[160:163], v201 offset:0
    ds_read_b64 v[184:185], v237 offset:24576
    buffer_load_dwordx4 v[188:189], s[28:31], 0 idxen offen offset:0 sc1 lds
    buffer_load_dwordx4 v[190:191], s[28:31], 0 idxen offen offset:1024 sc1 lds
    buffer_load_dwordx4 v[192:193], s[28:31], 0 idxen offen offset:2048 sc1 lds
    buffer_load_dwordx4 v[194:195], s[28:31], 0 idxen offen offset:3072 sc1 lds
    s_mov_b64 exec, s[56:57]
    v_fmac_f32 v20, v20, v106
    v_fmac_f32 v21, v21, v107
    v_fmac_f32 v22, v22, v108
    v_fmac_f32 v23, v23, v109
    v_fmac_f32 v24, v24, v110
    v_fmac_f32 v25, v25, v111
    v_fmac_f32 v26, v26, v112
    v_fmac_f32 v27, v27, v113
    v_fmac_f32 v28, v28, v114
    v_fmac_f32 v29, v29, v115
    v_fmac_f32 v30, v30, v116
    v_fmac_f32 v31, v31, v117
    v_fmac_f32 v32, v32, v118
    v_fmac_f32 v33, v33, v119
    v_fmac_f32 v34, v34, v120
    v_fmac_f32 v35, v35, v121
    v_fmac_f32 v20, v54, v88
    v_fmac_f32 v21, v55, v89
    v_fmac_f32 v22, v56, v90
    v_fmac_f32 v23, v57, v91
    v_fmac_f32 v24, v58, v92
    v_fmac_f32 v25, v59, v93
    v_fmac_f32 v26, v60, v94
    v_fmac_f32 v27, v61, v95
    v_fmac_f32 v28, v62, v96
    v_fmac_f32 v29, v63, v97
    v_fmac_f32 v30, v64, v98
    v_fmac_f32 v31, v65, v99
    v_fmac_f32 v32, v66, v100
    v_fmac_f32 v33, v67, v101
    v_fmac_f32 v34, v68, v102
    v_fmac_f32 v35, v69, v103
    v_fmac_f32 v88, v88, v106
    v_fmac_f32 v89, v89, v107
    v_fmac_f32 v90, v90, v108
    v_fmac_f32 v91, v91, v109
    v_fmac_f32 v92, v92, v110
    v_fmac_f32 v93, v93, v111
    v_fmac_f32 v94, v94, v112
    v_fmac_f32 v95, v95, v113
    v_fmac_f32 v96, v96, v114
    v_fmac_f32 v97, v97, v115
    v_fmac_f32 v98, v98, v116
    v_fmac_f32 v99, v99, v117
    v_fmac_f32 v100, v100, v118
    v_fmac_f32 v101, v101, v119
    v_fmac_f32 v102, v102, v120
    v_fmac_f32 v103, v103, v121
    s_setprio 2
    v_exp_f32 v106, v38
    v_exp_f32 v107, v39
    v_exp_f32 v108, v40
    v_mfma_f32_32x32x8_bf16 v[54:69], v[182:183], v[186:187], v[140:155]
    v_exp_f32 v109, v41
    v_exp_f32 v110, v42
    v_exp_f32 v111, v43
    v_exp_f32 v112, v44
    v_exp_f32 v113, v45
    v_smfmac_f32_32x32x32_bf16 v[54:69], v[172:175], v[164:171], v176
    v_exp_f32 v114, v46
    v_exp_f32 v115, v47
    v_exp_f32 v116, v48
    v_exp_f32 v117, v49
    v_exp_f32 v118, v50
    v_exp_f32 v119, v51
    v_exp_f32 v120, v52
    v_exp_f32 v121, v53
    s_setprio 0
    s_mov_b64 exec, -1
    s_waitcnt lgkmcnt(0)
    ds_read_b128 v[164:167], v202 offset:0
    ds_read_b128 v[168:171], v203 offset:0
    ds_read_u16 v188, v196 offset:32
    ds_read_u16 v190, v197 offset:32
    ds_read_u16 v192, v198 offset:32
    ds_read_u16 v194, v199 offset:32
    ds_read_u16 v237, v236 offset:30
    s_mov_b64 exec, s[58:59]
    v_fmac_f32 v4, v4, v106
    v_fmac_f32 v5, v5, v107
    v_fmac_f32 v6, v6, v108
    v_fmac_f32 v7, v7, v109
    v_fmac_f32 v8, v8, v110
    v_fmac_f32 v9, v9, v111
    v_fmac_f32 v10, v10, v112
    v_fmac_f32 v11, v11, v113
    v_fmac_f32 v12, v12, v114
    v_fmac_f32 v13, v13, v115
    v_fmac_f32 v14, v14, v116
    v_fmac_f32 v15, v15, v117
    v_fmac_f32 v16, v16, v118
    v_fmac_f32 v17, v17, v119
    v_fmac_f32 v18, v18, v120
    v_fmac_f32 v19, v19, v121
    v_fmac_f32 v4, v38, v72
    v_fmac_f32 v5, v39, v73
    v_fmac_f32 v6, v40, v74
    v_fmac_f32 v7, v41, v75
    v_fmac_f32 v8, v42, v76
    v_fmac_f32 v9, v43, v77
    v_fmac_f32 v10, v44, v78
    v_fmac_f32 v11, v45, v79
    v_fmac_f32 v12, v46, v80
    v_fmac_f32 v13, v47, v81
    v_fmac_f32 v14, v48, v82
    v_fmac_f32 v15, v49, v83
    v_fmac_f32 v16, v50, v84
    v_fmac_f32 v17, v51, v85
    v_fmac_f32 v18, v52, v86
    v_fmac_f32 v19, v53, v87
    v_fmac_f32 v72, v72, v106
    v_fmac_f32 v73, v73, v107
    v_fmac_f32 v74, v74, v108
    v_fmac_f32 v75, v75, v109
    v_fmac_f32 v76, v76, v110
    v_fmac_f32 v77, v77, v111
    v_fmac_f32 v78, v78, v112
    v_fmac_f32 v79, v79, v113
    v_fmac_f32 v80, v80, v114
    v_fmac_f32 v81, v81, v115
    v_fmac_f32 v82, v82, v116
    v_fmac_f32 v83, v83, v117
    v_fmac_f32 v84, v84, v118
    v_fmac_f32 v85, v85, v119
    v_fmac_f32 v86, v86, v120
    v_fmac_f32 v87, v87, v121
    s_setprio 2
    v_exp_f32 v106, v54
    v_exp_f32 v107, v55
    v_exp_f32 v108, v56
    v_mfma_f32_32x32x8_bf16 v[38:53], v[180:181], v[184:185], v[124:139]
    v_exp_f32 v109, v57
    v_exp_f32 v110, v58
    v_exp_f32 v111, v59
    v_exp_f32 v112, v60
    v_exp_f32 v113, v61
    v_smfmac_f32_32x32x32_bf16 v[38:53], v[172:175], v[156:163], v176
    v_exp_f32 v114, v62
    v_exp_f32 v115, v63
    v_exp_f32 v116, v64
    v_exp_f32 v117, v65
    v_exp_f32 v118, v66
    v_exp_f32 v119, v67
    v_exp_f32 v120, v68
    v_exp_f32 v121, v69
    s_setprio 0
    s_branch K_PGA1
.p2align 12
K_STA1:
    s_setpc_b64 s[0:1]
K_PGA1:
    s_mov_b64 exec, -1
    s_waitcnt vmcnt(0) lgkmcnt(0)
    s_add_u32 m0, s86, 0
    ds_read_b128 v[156:159], v200 offset:32768
    ds_read_b128 v[160:163], v201 offset:32768
    ds_read_b64 v[186:187], v237 offset:24576
    buffer_load_dwordx4 v[188:189], s[28:31], 0 idxen offen offset:0 sc1 lds
    buffer_load_dwordx4 v[190:191], s[28:31], 0 idxen offen offset:1024 sc1 lds
    buffer_load_dwordx4 v[192:193], s[28:31], 0 idxen offen offset:2048 sc1 lds
    buffer_load_dwordx4 v[194:195], s[28:31], 0 idxen offen offset:3072 sc1 lds
    s_mov_b64 exec, s[58:59]
    v_fmac_f32 v20, v20, v106
    v_fmac_f32 v21, v21, v107
    v_fmac_f32 v22, v22, v108
    v_fmac_f32 v23, v23, v109
    v_fmac_f32 v24, v24, v110
    v_fmac_f32 v25, v25, v111
    v_fmac_f32 v26, v26, v112
    v_fmac_f32 v27, v27, v113
    v_fmac_f32 v28, v28, v114
    v_fmac_f32 v29, v29, v115
    v_fmac_f32 v30, v30, v116
    v_fmac_f32 v31, v31, v117
    v_fmac_f32 v32, v32, v118
    v_fmac_f32 v33, v33, v119
    v_fmac_f32 v34, v34, v120
    v_fmac_f32 v35, v35, v121
    v_fmac_f32 v20, v54, v88
    v_fmac_f32 v21, v55, v89
    v_fmac_f32 v22, v56, v90
    v_fmac_f32 v23, v57, v91
    v_fmac_f32 v24, v58, v92
    v_fmac_f32 v25, v59, v93
    v_fmac_f32 v26, v60, v94
    v_fmac_f32 v27, v61, v95
    v_fmac_f32 v28, v62, v96
    v_fmac_f32 v29, v63, v97
    v_fmac_f32 v30, v64, v98
    v_fmac_f32 v31, v65, v99
    v_fmac_f32 v32, v66, v100
    v_fmac_f32 v33, v67, v101
    v_fmac_f32 v34, v68, v102
    v_fmac_f32 v35, v69, v103
    v_fmac_f32 v88, v88, v106
    v_fmac_f32 v89, v89, v107
    v_fmac_f32 v90, v90, v108
    v_fmac_f32 v91, v91, v109
    v_fmac_f32 v92, v92, v110
    v_fmac_f32 v93, v93, v111
    v_fmac_f32 v94, v94, v112
    v_fmac_f32 v95, v95, v113
    v_fmac_f32 v96, v96, v114
    v_fmac_f32 v97, v97, v115
    v_fmac_f32 v98, v98, v116
    v_fmac_f32 v99, v99, v117
    v_fmac_f32 v100, v100, v118
    v_fmac_f32 v101, v101, v119
    v_fmac_f32 v102, v102, v120
    v_fmac_f32 v103, v103, v121
    s_setprio 2
    v_exp_f32 v106, v38
    v_exp_f32 v107, v39
    v_exp_f32 v108, v40
    v_mfma_f32_32x32x8_bf16 v[54:69], v[182:183], v[184:185], v[140:155]
    v_exp_f32 v109, v41
    v_exp_f32 v110, v42
    v_exp_f32 v111, v43
    v_exp_f32 v112, v44
    v_exp_f32 v113, v45
    v_smfmac_f32_32x32x32_bf16 v[54:69], v[172:175], v[164:171], v176
    v_exp_f32 v114, v46
    v_exp_f32 v115, v47
    v_exp_f32 v116, v48
    v_exp_f32 v117, v49
    v_exp_f32 v118, v50
    v_exp_f32 v119, v51
    v_exp_f32 v120, v52
    v_exp_f32 v121, v53
    s_setprio 0
    s_mov_b64 exec, -1
    s_waitcnt lgkmcnt(0)
    ds_read_b128 v[164:167], v202 offset:32768
    ds_read_b128 v[168:171], v203 offset:32768
    ds_read_u16 v188, v196 offset:36
    ds_read_u16 v190, v197 offset:36
    ds_read_u16 v192, v198 offset:36
    ds_read_u16 v194, v199 offset:36
    ds_read_u16 v237, v236 offset:34
    s_mov_b64 exec, s[60:61]
    v_fmac_f32 v4, v4, v106
    v_fmac_f32 v5, v5, v107
    v_fmac_f32 v6, v6, v108
    v_fmac_f32 v7, v7, v109
    v_fmac_f32 v8, v8, v110
    v_fmac_f32 v9, v9, v111
    v_fmac_f32 v10, v10, v112
    v_fmac_f32 v11, v11, v113
    v_fmac_f32 v12, v12, v114
    v_fmac_f32 v13, v13, v115
    v_fmac_f32 v14, v14, v116
    v_fmac_f32 v15, v15, v117
    v_fmac_f32 v16, v16, v118
    v_fmac_f32 v17, v17, v119
    v_fmac_f32 v18, v18, v120
    v_fmac_f32 v19, v19, v121
    v_fmac_f32 v4, v38, v72
    v_fmac_f32 v5, v39, v73
    v_fmac_f32 v6, v40, v74
    v_fmac_f32 v7, v41, v75
    v_fmac_f32 v8, v42, v76
    v_fmac_f32 v9, v43, v77
    v_fmac_f32 v10, v44, v78
    v_fmac_f32 v11, v45, v79
    v_fmac_f32 v12, v46, v80
    v_fmac_f32 v13, v47, v81
    v_fmac_f32 v14, v48, v82
    v_fmac_f32 v15, v49, v83
    v_fmac_f32 v16, v50, v84
    v_fmac_f32 v17, v51, v85
    v_fmac_f32 v18, v52, v86
    v_fmac_f32 v19, v53, v87
    v_fmac_f32 v72, v72, v106
    v_fmac_f32 v73, v73, v107
    v_fmac_f32 v74, v74, v108
    v_fmac_f32 v75, v75, v109
    v_fmac_f32 v76, v76, v110
    v_fmac_f32 v77, v77, v111
    v_fmac_f32 v78, v78, v112
    v_fmac_f32 v79, v79, v113
    v_fmac_f32 v80, v80, v114
    v_fmac_f32 v81, v81, v115
    v_fmac_f32 v82, v82, v116
    v_fmac_f32 v83, v83, v117
    v_fmac_f32 v84, v84, v118
    v_fmac_f32 v85, v85, v119
    v_fmac_f32 v86, v86, v120
    v_fmac_f32 v87, v87, v121
    s_setprio 2
    v_exp_f32 v106, v54
    v_exp_f32 v107, v55
    v_exp_f32 v108, v56
    v_mfma_f32_32x32x8_bf16 v[38:53], v[180:181], v[186:187], v[124:139]
    v_exp_f32 v109, v57
    v_exp_f32 v110, v58
    v_exp_f32 v111, v59
    v_exp_f32 v112, v60
    v_exp_f32 v113, v61
    v_smfmac_f32_32x32x32_bf16 v[38:53], v[172:175], v[156:163], v176
    v_exp_f32 v114, v62
    v_exp_f32 v115, v63
    v_exp_f32 v116, v64
    v_exp_f32 v117, v65
    v_exp_f32 v118, v66
    v_exp_f32 v119, v67
    v_exp_f32 v120, v68
    v_exp_f32 v121, v69
    s_setprio 0
    s_mov_b64 exec, -1
    s_waitcnt vmcnt(0) lgkmcnt(0)
    s_add_u32 m0, s86, 32768
    ds_read_b128 v[156:159], v200 offset:0
    ds_read_b128 v[160:163], v201 offset:0
    ds_read_b64 v[184:185], v237 offset:24576
    buffer_load_dwordx4 v[188:189], s[28:31], 0 idxen offen offset:0 sc1 lds
    buffer_load_dwordx4 v[190:191], s[28:31], 0 idxen offen offset:1024 sc1 lds
    buffer_load_dwordx4 v[192:193], s[28:31], 0 idxen offen offset:2048 sc1 lds
    buffer_load_dwordx4 v[194:195], s[28:31], 0 idxen offen offset:3072 sc1 lds
    s_mov_b64 exec, s[60:61]
    v_fmac_f32 v20, v20, v106
    v_fmac_f32 v21, v21, v107
    v_fmac_f32 v22, v22, v108
    v_fmac_f32 v23, v23, v109
    v_fmac_f32 v24, v24, v110
    v_fmac_f32 v25, v25, v111
    v_fmac_f32 v26, v26, v112
    v_fmac_f32 v27, v27, v113
    v_fmac_f32 v28, v28, v114
    v_fmac_f32 v29, v29, v115
    v_fmac_f32 v30, v30, v116
    v_fmac_f32 v31, v31, v117
    v_fmac_f32 v32, v32, v118
    v_fmac_f32 v33, v33, v119
    v_fmac_f32 v34, v34, v120
    v_fmac_f32 v35, v35, v121
    v_fmac_f32 v20, v54, v88
    v_fmac_f32 v21, v55, v89
    v_fmac_f32 v22, v56, v90
    v_fmac_f32 v23, v57, v91
    v_fmac_f32 v24, v58, v92
    v_fmac_f32 v25, v59, v93
    v_fmac_f32 v26, v60, v94
    v_fmac_f32 v27, v61, v95
    v_fmac_f32 v28, v62, v96
    v_fmac_f32 v29, v63, v97
    v_fmac_f32 v30, v64, v98
    v_fmac_f32 v31, v65, v99
    v_fmac_f32 v32, v66, v100
    v_fmac_f32 v33, v67, v101
    v_fmac_f32 v34, v68, v102
    v_fmac_f32 v35, v69, v103
    v_fmac_f32 v88, v88, v106
    v_fmac_f32 v89, v89, v107
    v_fmac_f32 v90, v90, v108
    v_fmac_f32 v91, v91, v109
    v_fmac_f32 v92, v92, v110
    v_fmac_f32 v93, v93, v111
    v_fmac_f32 v94, v94, v112
    v_fmac_f32 v95, v95, v113
    v_fmac_f32 v96, v96, v114
    v_fmac_f32 v97, v97, v115
    v_fmac_f32 v98, v98, v116
    v_fmac_f32 v99, v99, v117
    v_fmac_f32 v100, v100, v118
    v_fmac_f32 v101, v101, v119
    v_fmac_f32 v102, v102, v120
    v_fmac_f32 v103, v103, v121
    s_setprio 2
    v_exp_f32 v106, v38
    v_exp_f32 v107, v39
    v_exp_f32 v108, v40
    v_mfma_f32_32x32x8_bf16 v[54:69], v[182:183], v[186:187], v[140:155]
    v_exp_f32 v109, v41
    v_exp_f32 v110, v42
    v_exp_f32 v111, v43
    v_exp_f32 v112, v44
    v_exp_f32 v113, v45
    v_smfmac_f32_32x32x32_bf16 v[54:69], v[172:175], v[164:171], v176
    v_exp_f32 v114, v46
    v_exp_f32 v115, v47
    v_exp_f32 v116, v48
    v_exp_f32 v117, v49
    v_exp_f32 v118, v50
    v_exp_f32 v119, v51
    v_exp_f32 v120, v52
    v_exp_f32 v121, v53
    s_setprio 0
    s_mov_b64 exec, -1
    s_waitcnt lgkmcnt(0)
    ds_read_b128 v[164:167], v202 offset:0
    ds_read_b128 v[168:171], v203 offset:0
    ds_read_u16 v188, v196 offset:40
    ds_read_u16 v190, v197 offset:40
    ds_read_u16 v192, v198 offset:40
    ds_read_u16 v194, v199 offset:40
    ds_read_u16 v237, v236 offset:38
    s_mov_b64 exec, s[62:63]
    v_fmac_f32 v4, v4, v106
    v_fmac_f32 v5, v5, v107
    v_fmac_f32 v6, v6, v108
    v_fmac_f32 v7, v7, v109
    v_fmac_f32 v8, v8, v110
    v_fmac_f32 v9, v9, v111
    v_fmac_f32 v10, v10, v112
    v_fmac_f32 v11, v11, v113
    v_fmac_f32 v12, v12, v114
    v_fmac_f32 v13, v13, v115
    v_fmac_f32 v14, v14, v116
    v_fmac_f32 v15, v15, v117
    v_fmac_f32 v16, v16, v118
    v_fmac_f32 v17, v17, v119
    v_fmac_f32 v18, v18, v120
    v_fmac_f32 v19, v19, v121
    v_fmac_f32 v4, v38, v72
    v_fmac_f32 v5, v39, v73
    v_fmac_f32 v6, v40, v74
    v_fmac_f32 v7, v41, v75
    v_fmac_f32 v8, v42, v76
    v_fmac_f32 v9, v43, v77
    v_fmac_f32 v10, v44, v78
    v_fmac_f32 v11, v45, v79
    v_fmac_f32 v12, v46, v80
    v_fmac_f32 v13, v47, v81
    v_fmac_f32 v14, v48, v82
    v_fmac_f32 v15, v49, v83
    v_fmac_f32 v16, v50, v84
    v_fmac_f32 v17, v51, v85
    v_fmac_f32 v18, v52, v86
    v_fmac_f32 v19, v53, v87
    v_fmac_f32 v72, v72, v106
    v_fmac_f32 v73, v73, v107
    v_fmac_f32 v74, v74, v108
    v_fmac_f32 v75, v75, v109
    v_fmac_f32 v76, v76, v110
    v_fmac_f32 v77, v77, v111
    v_fmac_f32 v78, v78, v112
    v_fmac_f32 v79, v79, v113
    v_fmac_f32 v80, v80, v114
    v_fmac_f32 v81, v81, v115
    v_fmac_f32 v82, v82, v116
    v_fmac_f32 v83, v83, v117
    v_fmac_f32 v84, v84, v118
    v_fmac_f32 v85, v85, v119
    v_fmac_f32 v86, v86, v120
    v_fmac_f32 v87, v87, v121
    s_setprio 2
    v_exp_f32 v106, v54
    v_exp_f32 v107, v55
    v_exp_f32 v108, v56
    v_mfma_f32_32x32x8_bf16 v[38:53], v[180:181], v[184:185], v[124:139]
    v_exp_f32 v109, v57
    v_exp_f32 v110, v58
    v_exp_f32 v111, v59
    v_exp_f32 v112, v60
    v_exp_f32 v113, v61
    v_smfmac_f32_32x32x32_bf16 v[38:53], v[172:175], v[156:163], v176
    v_exp_f32 v114, v62
    v_exp_f32 v115, v63
    v_exp_f32 v116, v64
    v_exp_f32 v117, v65
    v_exp_f32 v118, v66
    v_exp_f32 v119, v67
    v_exp_f32 v120, v68
    v_exp_f32 v121, v69
    s_setprio 0
    s_mov_b64 exec, -1
    s_waitcnt vmcnt(0) lgkmcnt(0)
    s_add_u32 m0, s86, 0
    ds_read_b128 v[156:159], v200 offset:32768
    ds_read_b128 v[160:163], v201 offset:32768
    ds_read_b64 v[186:187], v237 offset:24576
    buffer_load_dwordx4 v[188:189], s[28:31], 0 idxen offen offset:0 sc1 lds
    buffer_load_dwordx4 v[190:191], s[28:31], 0 idxen offen offset:1024 sc1 lds
    buffer_load_dwordx4 v[192:193], s[28:31], 0 idxen offen offset:2048 sc1 lds
    buffer_load_dwordx4 v[194:195], s[28:31], 0 idxen offen offset:3072 sc1 lds
    s_mov_b64 exec, s[62:63]
    v_fmac_f32 v20, v20, v106
    v_fmac_f32 v21, v21, v107
    v_fmac_f32 v22, v22, v108
    v_fmac_f32 v23, v23, v109
    v_fmac_f32 v24, v24, v110
    v_fmac_f32 v25, v25, v111
    v_fmac_f32 v26, v26, v112
    v_fmac_f32 v27, v27, v113
    v_fmac_f32 v28, v28, v114
    v_fmac_f32 v29, v29, v115
    v_fmac_f32 v30, v30, v116
    v_fmac_f32 v31, v31, v117
    v_fmac_f32 v32, v32, v118
    v_fmac_f32 v33, v33, v119
    v_fmac_f32 v34, v34, v120
    v_fmac_f32 v35, v35, v121
    v_fmac_f32 v20, v54, v88
    v_fmac_f32 v21, v55, v89
    v_fmac_f32 v22, v56, v90
    v_fmac_f32 v23, v57, v91
    v_fmac_f32 v24, v58, v92
    v_fmac_f32 v25, v59, v93
    v_fmac_f32 v26, v60, v94
    v_fmac_f32 v27, v61, v95
    v_fmac_f32 v28, v62, v96
    v_fmac_f32 v29, v63, v97
    v_fmac_f32 v30, v64, v98
    v_fmac_f32 v31, v65, v99
    v_fmac_f32 v32, v66, v100
    v_fmac_f32 v33, v67, v101
    v_fmac_f32 v34, v68, v102
    v_fmac_f32 v35, v69, v103
    v_fmac_f32 v88, v88, v106
    v_fmac_f32 v89, v89, v107
    v_fmac_f32 v90, v90, v108
    v_fmac_f32 v91, v91, v109
    v_fmac_f32 v92, v92, v110
    v_fmac_f32 v93, v93, v111
    v_fmac_f32 v94, v94, v112
    v_fmac_f32 v95, v95, v113
    v_fmac_f32 v96, v96, v114
    v_fmac_f32 v97, v97, v115
    v_fmac_f32 v98, v98, v116
    v_fmac_f32 v99, v99, v117
    v_fmac_f32 v100, v100, v118
    v_fmac_f32 v101, v101, v119
    v_fmac_f32 v102, v102, v120
    v_fmac_f32 v103, v103, v121
    s_setprio 2
    v_exp_f32 v106, v38
    v_exp_f32 v107, v39
    v_exp_f32 v108, v40
    v_mfma_f32_32x32x8_bf16 v[54:69], v[182:183], v[184:185], v[140:155]
    v_exp_f32 v109, v41
    v_exp_f32 v110, v42
    v_exp_f32 v111, v43
    v_exp_f32 v112, v44
    v_exp_f32 v113, v45
    v_smfmac_f32_32x32x32_bf16 v[54:69], v[172:175], v[164:171], v176
    v_exp_f32 v114, v46
    v_exp_f32 v115, v47
    v_exp_f32 v116, v48
    v_exp_f32 v117, v49
    v_exp_f32 v118, v50
    v_exp_f32 v119, v51
    v_exp_f32 v120, v52
    v_exp_f32 v121, v53
    s_setprio 0
    s_mov_b64 exec, -1
    s_waitcnt lgkmcnt(0)
    ds_read_b128 v[164:167], v202 offset:32768
    ds_read_b128 v[168:171], v203 offset:32768
    ds_read_u16 v188, v196 offset:44
    ds_read_u16 v190, v197 offset:44
    ds_read_u16 v192, v198 offset:44
    ds_read_u16 v194, v199 offset:44
    ds_read_u16 v237, v236 offset:42
    s_mov_b64 exec, s[64:65]
    v_fmac_f32 v4, v4, v106
    v_fmac_f32 v5, v5, v107
    v_fmac_f32 v6, v6, v108
    v_fmac_f32 v7, v7, v109
    v_fmac_f32 v8, v8, v110
    v_fmac_f32 v9, v9, v111
    v_fmac_f32 v10, v10, v112
    v_fmac_f32 v11, v11, v113
    v_fmac_f32 v12, v12, v114
    v_fmac_f32 v13, v13, v115
    v_fmac_f32 v14, v14, v116
    v_fmac_f32 v15, v15, v117
    v_fmac_f32 v16, v16, v118
    v_fmac_f32 v17, v17, v119
    v_fmac_f32 v18, v18, v120
    v_fmac_f32 v19, v19, v121
    v_fmac_f32 v4, v38, v72
    v_fmac_f32 v5, v39, v73
    v_fmac_f32 v6, v40, v74
    v_fmac_f32 v7, v41, v75
    v_fmac_f32 v8, v42, v76
    v_fmac_f32 v9, v43, v77
    v_fmac_f32 v10, v44, v78
    v_fmac_f32 v11, v45, v79
    v_fmac_f32 v12, v46, v80
    v_fmac_f32 v13, v47, v81
    v_fmac_f32 v14, v48, v82
    v_fmac_f32 v15, v49, v83
    v_fmac_f32 v16, v50, v84
    v_fmac_f32 v17, v51, v85
    v_fmac_f32 v18, v52, v86
    v_fmac_f32 v19, v53, v87
    v_fmac_f32 v72, v72, v106
    v_fmac_f32 v73, v73, v107
    v_fmac_f32 v74, v74, v108
    v_fmac_f32 v75, v75, v109
    v_fmac_f32 v76, v76, v110
    v_fmac_f32 v77, v77, v111
    v_fmac_f32 v78, v78, v112
    v_fmac_f32 v79, v79, v113
    v_fmac_f32 v80, v80, v114
    v_fmac_f32 v81, v81, v115
    v_fmac_f32 v82, v82, v116
    v_fmac_f32 v83, v83, v117
    v_fmac_f32 v84, v84, v118
    v_fmac_f32 v85, v85, v119
    v_fmac_f32 v86, v86, v120
    v_fmac_f32 v87, v87, v121
    s_setprio 2
    v_exp_f32 v106, v54
    v_exp_f32 v107, v55
    v_exp_f32 v108, v56
    v_mfma_f32_32x32x8_bf16 v[38:53], v[180:181], v[186:187], v[124:139]
    v_exp_f32 v109, v57
    v_exp_f32 v110, v58
    v_exp_f32 v111, v59
    v_exp_f32 v112, v60
    v_exp_f32 v113, v61
    v_smfmac_f32_32x32x32_bf16 v[38:53], v[172:175], v[156:163], v176
    v_exp_f32 v114, v62
    v_exp_f32 v115, v63
    v_exp_f32 v116, v64
    v_exp_f32 v117, v65
    v_exp_f32 v118, v66
    v_exp_f32 v119, v67
    v_exp_f32 v120, v68
    v_exp_f32 v121, v69
    s_setprio 0
    s_mov_b64 exec, -1
    s_waitcnt vmcnt(0) lgkmcnt(0)
    s_add_u32 m0, s86, 32768
    ds_read_b128 v[156:159], v200 offset:0
    ds_read_b128 v[160:163], v201 offset:0
    ds_read_b64 v[184:185], v237 offset:24576
    buffer_load_dwordx4 v[188:189], s[28:31], 0 idxen offen offset:0 sc1 lds
    buffer_load_dwordx4 v[190:191], s[28:31], 0 idxen offen offset:1024 sc1 lds
    buffer_load_dwordx4 v[192:193], s[28:31], 0 idxen offen offset:2048 sc1 lds
    buffer_load_dwordx4 v[194:195], s[28:31], 0 idxen offen offset:3072 sc1 lds
    s_mov_b64 exec, s[64:65]
    v_fmac_f32 v20, v20, v106
    v_fmac_f32 v21, v21, v107
    v_fmac_f32 v22, v22, v108
    v_fmac_f32 v23, v23, v109
    v_fmac_f32 v24, v24, v110
    v_fmac_f32 v25, v25, v111
    v_fmac_f32 v26, v26, v112
    v_fmac_f32 v27, v27, v113
    v_fmac_f32 v28, v28, v114
    v_fmac_f32 v29, v29, v115
    v_fmac_f32 v30, v30, v116
    v_fmac_f32 v31, v31, v117
    v_fmac_f32 v32, v32, v118
    v_fmac_f32 v33, v33, v119
    v_fmac_f32 v34, v34, v120
    v_fmac_f32 v35, v35, v121
    v_fmac_f32 v20, v54, v88
    v_fmac_f32 v21, v55, v89
    v_fmac_f32 v22, v56, v90
    v_fmac_f32 v23, v57, v91
    v_fmac_f32 v24, v58, v92
    v_fmac_f32 v25, v59, v93
    v_fmac_f32 v26, v60, v94
    v_fmac_f32 v27, v61, v95
    v_fmac_f32 v28, v62, v96
    v_fmac_f32 v29, v63, v97
    v_fmac_f32 v30, v64, v98
    v_fmac_f32 v31, v65, v99
    v_fmac_f32 v32, v66, v100
    v_fmac_f32 v33, v67, v101
    v_fmac_f32 v34, v68, v102
    v_fmac_f32 v35, v69, v103
    v_fmac_f32 v88, v88, v106
    v_fmac_f32 v89, v89, v107
    v_fmac_f32 v90, v90, v108
    v_fmac_f32 v91, v91, v109
    v_fmac_f32 v92, v92, v110
    v_fmac_f32 v93, v93, v111
    v_fmac_f32 v94, v94, v112
    v_fmac_f32 v95, v95, v113
    v_fmac_f32 v96, v96, v114
    v_fmac_f32 v97, v97, v115
    v_fmac_f32 v98, v98, v116
    v_fmac_f32 v99, v99, v117
    v_fmac_f32 v100, v100, v118
    v_fmac_f32 v101, v101, v119
    v_fmac_f32 v102, v102, v120
    v_fmac_f32 v103, v103, v121
    s_setprio 2
    v_exp_f32 v106, v38
    v_exp_f32 v107, v39
    v_exp_f32 v108, v40
    v_mfma_f32_32x32x8_bf16 v[54:69], v[182:183], v[186:187], v[140:155]
    v_exp_f32 v109, v41
    v_exp_f32 v110, v42
    v_exp_f32 v111, v43
    v_exp_f32 v112, v44
    v_exp_f32 v113, v45
    v_smfmac_f32_32x32x32_bf16 v[54:69], v[172:175], v[164:171], v176
    v_exp_f32 v114, v46
    v_exp_f32 v115, v47
    v_exp_f32 v116, v48
    v_exp_f32 v117, v49
    v_exp_f32 v118, v50
    v_exp_f32 v119, v51
    v_exp_f32 v120, v52
    v_exp_f32 v121, v53
    s_setprio 0
    s_mov_b64 exec, -1
    s_waitcnt lgkmcnt(0)
    ds_read_b128 v[164:167], v202 offset:0
    ds_read_b128 v[168:171], v203 offset:0
    ds_read_u16 v188, v196 offset:48
    ds_read_u16 v190, v197 offset:48
    ds_read_u16 v192, v198 offset:48
    ds_read_u16 v194, v199 offset:48
    ds_read_u16 v237, v236 offset:46
    s_mov_b64 exec, s[66:67]
    v_fmac_f32 v4, v4, v106
    v_fmac_f32 v5, v5, v107
    v_fmac_f32 v6, v6, v108
    v_fmac_f32 v7, v7, v109
    v_fmac_f32 v8, v8, v110
    v_fmac_f32 v9, v9, v111
    v_fmac_f32 v10, v10, v112
    v_fmac_f32 v11, v11, v113
    v_fmac_f32 v12, v12, v114
    v_fmac_f32 v13, v13, v115
    v_fmac_f32 v14, v14, v116
    v_fmac_f32 v15, v15, v117
    v_fmac_f32 v16, v16, v118
    v_fmac_f32 v17, v17, v119
    v_fmac_f32 v18, v18, v120
    v_fmac_f32 v19, v19, v121
    v_fmac_f32 v4, v38, v72
    v_fmac_f32 v5, v39, v73
    v_fmac_f32 v6, v40, v74
    v_fmac_f32 v7, v41, v75
    v_fmac_f32 v8, v42, v76
    v_fmac_f32 v9, v43, v77
    v_fmac_f32 v10, v44, v78
    v_fmac_f32 v11, v45, v79
    v_fmac_f32 v12, v46, v80
    v_fmac_f32 v13, v47, v81
    v_fmac_f32 v14, v48, v82
    v_fmac_f32 v15, v49, v83
    v_fmac_f32 v16, v50, v84
    v_fmac_f32 v17, v51, v85
    v_fmac_f32 v18, v52, v86
    v_fmac_f32 v19, v53, v87
    v_fmac_f32 v72, v72, v106
    v_fmac_f32 v73, v73, v107
    v_fmac_f32 v74, v74, v108
    v_fmac_f32 v75, v75, v109
    v_fmac_f32 v76, v76, v110
    v_fmac_f32 v77, v77, v111
    v_fmac_f32 v78, v78, v112
    v_fmac_f32 v79, v79, v113
    v_fmac_f32 v80, v80, v114
    v_fmac_f32 v81, v81, v115
    v_fmac_f32 v82, v82, v116
    v_fmac_f32 v83, v83, v117
    v_fmac_f32 v84, v84, v118
    v_fmac_f32 v85, v85, v119
    v_fmac_f32 v86, v86, v120
    v_fmac_f32 v87, v87, v121
    s_setprio 2
    v_exp_f32 v106, v54
    v_exp_f32 v107, v55
    v_exp_f32 v108, v56
    v_mfma_f32_32x32x8_bf16 v[38:53], v[180:181], v[184:185], v[124:139]
    v_exp_f32 v109, v57
    v_exp_f32 v110, v58
    v_exp_f32 v111, v59
    v_exp_f32 v112, v60
    v_exp_f32 v113, v61
    v_smfmac_f32_32x32x32_bf16 v[38:53], v[172:175], v[156:163], v176
    v_exp_f32 v114, v62
    v_exp_f32 v115, v63
    v_exp_f32 v116, v64
    v_exp_f32 v117, v65
    v_exp_f32 v118, v66
    v_exp_f32 v119, v67
    v_exp_f32 v120, v68
    v_exp_f32 v121, v69
    s_setprio 0
    s_mov_b64 exec, -1
    s_waitcnt vmcnt(0) lgkmcnt(0)
    s_add_u32 m0, s86, 0
    ds_read_b128 v[156:159], v200 offset:32768
    ds_read_b128 v[160:163], v201 offset:32768
    ds_read_b64 v[186:187], v237 offset:24576
    buffer_load_dwordx4 v[188:189], s[28:31], 0 idxen offen offset:0 sc1 lds
    buffer_load_dwordx4 v[190:191], s[28:31], 0 idxen offen offset:1024 sc1 lds
    buffer_load_dwordx4 v[192:193], s[28:31], 0 idxen offen offset:2048 sc1 lds
    buffer_load_dwordx4 v[194:195], s[28:31], 0 idxen offen offset:3072 sc1 lds
    s_mov_b64 exec, s[66:67]
    v_fmac_f32 v20, v20, v106
    v_fmac_f32 v21, v21, v107
    v_fmac_f32 v22, v22, v108
    v_fmac_f32 v23, v23, v109
    v_fmac_f32 v24, v24, v110
    v_fmac_f32 v25, v25, v111
    v_fmac_f32 v26, v26, v112
    v_fmac_f32 v27, v27, v113
    v_fmac_f32 v28, v28, v114
    v_fmac_f32 v29, v29, v115
    v_fmac_f32 v30, v30, v116
    v_fmac_f32 v31, v31, v117
    v_fmac_f32 v32, v32, v118
    v_fmac_f32 v33, v33, v119
    v_fmac_f32 v34, v34, v120
    v_fmac_f32 v35, v35, v121
    v_fmac_f32 v20, v54, v88
    v_fmac_f32 v21, v55, v89
    v_fmac_f32 v22, v56, v90
    v_fmac_f32 v23, v57, v91
    v_fmac_f32 v24, v58, v92
    v_fmac_f32 v25, v59, v93
    v_fmac_f32 v26, v60, v94
    v_fmac_f32 v27, v61, v95
    v_fmac_f32 v28, v62, v96
    v_fmac_f32 v29, v63, v97
    v_fmac_f32 v30, v64, v98
    v_fmac_f32 v31, v65, v99
    v_fmac_f32 v32, v66, v100
    v_fmac_f32 v33, v67, v101
    v_fmac_f32 v34, v68, v102
    v_fmac_f32 v35, v69, v103
    v_fmac_f32 v88, v88, v106
    v_fmac_f32 v89, v89, v107
    v_fmac_f32 v90, v90, v108
    v_fmac_f32 v91, v91, v109
    v_fmac_f32 v92, v92, v110
    v_fmac_f32 v93, v93, v111
    v_fmac_f32 v94, v94, v112
    v_fmac_f32 v95, v95, v113
    v_fmac_f32 v96, v96, v114
    v_fmac_f32 v97, v97, v115
    v_fmac_f32 v98, v98, v116
    v_fmac_f32 v99, v99, v117
    v_fmac_f32 v100, v100, v118
    v_fmac_f32 v101, v101, v119
    v_fmac_f32 v102, v102, v120
    v_fmac_f32 v103, v103, v121
    s_setprio 2
    v_exp_f32 v106, v38
    v_exp_f32 v107, v39
    v_exp_f32 v108, v40
    v_mfma_f32_32x32x8_bf16 v[54:69], v[182:183], v[184:185], v[140:155]
    v_exp_f32 v109, v41
    v_exp_f32 v110, v42
    v_exp_f32 v111, v43
    v_exp_f32 v112, v44
    v_exp_f32 v113, v45
    v_smfmac_f32_32x32x32_bf16 v[54:69], v[172:175], v[164:171], v176
    v_exp_f32 v114, v46
    v_exp_f32 v115, v47
    v_exp_f32 v116, v48
    v_exp_f32 v117, v49
    v_exp_f32 v118, v50
    v_exp_f32 v119, v51
    v_exp_f32 v120, v52
    v_exp_f32 v121, v53
    s_setprio 0
    s_mov_b64 exec, -1
    s_waitcnt lgkmcnt(0)
    ds_read_b128 v[164:167], v202 offset:32768
    ds_read_b128 v[168:171], v203 offset:32768
    ds_read_u16 v188, v196 offset:52
    ds_read_u16 v190, v197 offset:52
    ds_read_u16 v192, v198 offset:52
    ds_read_u16 v194, v199 offset:52
    ds_read_u16 v237, v236 offset:50
    s_mov_b64 exec, s[68:69]
    v_fmac_f32 v4, v4, v106
    v_fmac_f32 v5, v5, v107
    v_fmac_f32 v6, v6, v108
    v_fmac_f32 v7, v7, v109
    v_fmac_f32 v8, v8, v110
    v_fmac_f32 v9, v9, v111
    v_fmac_f32 v10, v10, v112
    v_fmac_f32 v11, v11, v113
    v_fmac_f32 v12, v12, v114
    v_fmac_f32 v13, v13, v115
    v_fmac_f32 v14, v14, v116
    v_fmac_f32 v15, v15, v117
    v_fmac_f32 v16, v16, v118
    v_fmac_f32 v17, v17, v119
    v_fmac_f32 v18, v18, v120
    v_fmac_f32 v19, v19, v121
    v_fmac_f32 v4, v38, v72
    v_fmac_f32 v5, v39, v73
    v_fmac_f32 v6, v40, v74
    v_fmac_f32 v7, v41, v75
    v_fmac_f32 v8, v42, v76
    v_fmac_f32 v9, v43, v77
    v_fmac_f32 v10, v44, v78
    v_fmac_f32 v11, v45, v79
    v_fmac_f32 v12, v46, v80
    v_fmac_f32 v13, v47, v81
    v_fmac_f32 v14, v48, v82
    v_fmac_f32 v15, v49, v83
    v_fmac_f32 v16, v50, v84
    v_fmac_f32 v17, v51, v85
    v_fmac_f32 v18, v52, v86
    v_fmac_f32 v19, v53, v87
    v_fmac_f32 v72, v72, v106
    v_fmac_f32 v73, v73, v107
    v_fmac_f32 v74, v74, v108
    v_fmac_f32 v75, v75, v109
    v_fmac_f32 v76, v76, v110
    v_fmac_f32 v77, v77, v111
    v_fmac_f32 v78, v78, v112
    v_fmac_f32 v79, v79, v113
    v_fmac_f32 v80, v80, v114
    v_fmac_f32 v81, v81, v115
    v_fmac_f32 v82, v82, v116
    v_fmac_f32 v83, v83, v117
    v_fmac_f32 v84, v84, v118
    v_fmac_f32 v85, v85, v119
    v_fmac_f32 v86, v86, v120
    v_fmac_f32 v87, v87, v121
    s_setprio 2
    v_exp_f32 v106, v54
    v_exp_f32 v107, v55
    v_exp_f32 v108, v56
    v_mfma_f32_32x32x8_bf16 v[38:53], v[180:181], v[186:187], v[124:139]
    v_exp_f32 v109, v57
    v_exp_f32 v110, v58
    v_exp_f32 v111, v59
    v_exp_f32 v112, v60
    v_exp_f32 v113, v61
    v_smfmac_f32_32x32x32_bf16 v[38:53], v[172:175], v[156:163], v176
    v_exp_f32 v114, v62
    v_exp_f32 v115, v63
    v_exp_f32 v116, v64
    v_exp_f32 v117, v65
    v_exp_f32 v118, v66
    v_exp_f32 v119, v67
    v_exp_f32 v120, v68
    v_exp_f32 v121, v69
    s_setprio 0
    s_mov_b64 exec, -1
    s_waitcnt vmcnt(0) lgkmcnt(0)
    s_add_u32 m0, s86, 32768
    ds_read_b128 v[156:159], v200 offset:0
    ds_read_b128 v[160:163], v201 offset:0
    ds_read_b64 v[184:185], v237 offset:24576
    buffer_load_dwordx4 v[188:189], s[28:31], 0 idxen offen offset:0 sc1 lds
    buffer_load_dwordx4 v[190:191], s[28:31], 0 idxen offen offset:1024 sc1 lds
    buffer_load_dwordx4 v[192:193], s[28:31], 0 idxen offen offset:2048 sc1 lds
    buffer_load_dwordx4 v[194:195], s[28:31], 0 idxen offen offset:3072 sc1 lds
    s_mov_b64 exec, s[68:69]
    v_fmac_f32 v20, v20, v106
    v_fmac_f32 v21, v21, v107
    v_fmac_f32 v22, v22, v108
    v_fmac_f32 v23, v23, v109
    v_fmac_f32 v24, v24, v110
    v_fmac_f32 v25, v25, v111
    v_fmac_f32 v26, v26, v112
    v_fmac_f32 v27, v27, v113
    v_fmac_f32 v28, v28, v114
    v_fmac_f32 v29, v29, v115
    v_fmac_f32 v30, v30, v116
    v_fmac_f32 v31, v31, v117
    v_fmac_f32 v32, v32, v118
    v_fmac_f32 v33, v33, v119
    v_fmac_f32 v34, v34, v120
    v_fmac_f32 v35, v35, v121
    v_fmac_f32 v20, v54, v88
    v_fmac_f32 v21, v55, v89
    v_fmac_f32 v22, v56, v90
    v_fmac_f32 v23, v57, v91
    v_fmac_f32 v24, v58, v92
    v_fmac_f32 v25, v59, v93
    v_fmac_f32 v26, v60, v94
    v_fmac_f32 v27, v61, v95
    v_fmac_f32 v28, v62, v96
    v_fmac_f32 v29, v63, v97
    v_fmac_f32 v30, v64, v98
    v_fmac_f32 v31, v65, v99
    v_fmac_f32 v32, v66, v100
    v_fmac_f32 v33, v67, v101
    v_fmac_f32 v34, v68, v102
    v_fmac_f32 v35, v69, v103
    v_fmac_f32 v88, v88, v106
    v_fmac_f32 v89, v89, v107
    v_fmac_f32 v90, v90, v108
    v_fmac_f32 v91, v91, v109
    v_fmac_f32 v92, v92, v110
    v_fmac_f32 v93, v93, v111
    v_fmac_f32 v94, v94, v112
    v_fmac_f32 v95, v95, v113
    v_fmac_f32 v96, v96, v114
    v_fmac_f32 v97, v97, v115
    v_fmac_f32 v98, v98, v116
    v_fmac_f32 v99, v99, v117
    v_fmac_f32 v100, v100, v118
    v_fmac_f32 v101, v101, v119
    v_fmac_f32 v102, v102, v120
    v_fmac_f32 v103, v103, v121
    s_setprio 2
    v_exp_f32 v106, v38
    v_exp_f32 v107, v39
    v_exp_f32 v108, v40
    v_mfma_f32_32x32x8_bf16 v[54:69], v[182:183], v[186:187], v[140:155]
    v_exp_f32 v109, v41
    v_exp_f32 v110, v42
    v_exp_f32 v111, v43
    v_exp_f32 v112, v44
    v_exp_f32 v113, v45
    v_smfmac_f32_32x32x32_bf16 v[54:69], v[172:175], v[164:171], v176
    v_exp_f32 v114, v46
    v_exp_f32 v115, v47
    v_exp_f32 v116, v48
    v_exp_f32 v117, v49
    v_exp_f32 v118, v50
    v_exp_f32 v119, v51
    v_exp_f32 v120, v52
    v_exp_f32 v121, v53
    s_setprio 0
    s_branch K_PGA2
.p2align 12
K_STA2:
    s_setpc_b64 s[0:1]
K_PGA2:
    s_mov_b64 exec, -1
    s_waitcnt lgkmcnt(0)
    ds_read_b128 v[164:167], v202 offset:0
    ds_read_b128 v[168:171], v203 offset:0
    ds_read_u16 v188, v196 offset:56
    ds_read_u16 v190, v197 offset:56
    ds_read_u16 v192, v198 offset:56
    ds_read_u16 v194, v199 offset:56
    ds_read_u16 v237, v236 offset:54
    s_mov_b64 exec, s[70:71]
    v_fmac_f32 v4, v4, v106
    v_fmac_f32 v5, v5, v107
    v_fmac_f32 v6, v6, v108
    v_fmac_f32 v7, v7, v109
    v_fmac_f32 v8, v8, v110
    v_fmac_f32 v9, v9, v111
    v_fmac_f32 v10, v10, v112
    v_fmac_f32 v11, v11, v113
    v_fmac_f32 v12, v12, v114
    v_fmac_f32 v13, v13, v115
    v_fmac_f32 v14, v14, v116
    v_fmac_f32 v15, v15, v117
    v_fmac_f32 v16, v16, v118
    v_fmac_f32 v17, v17, v119
    v_fmac_f32 v18, v18, v120
    v_fmac_f32 v19, v19, v121
    v_fmac_f32 v4, v38, v72
    v_fmac_f32 v5, v39, v73
    v_fmac_f32 v6, v40, v74
    v_fmac_f32 v7, v41, v75
    v_fmac_f32 v8, v42, v76
    v_fmac_f32 v9, v43, v77
    v_fmac_f32 v10, v44, v78
    v_fmac_f32 v11, v45, v79
    v_fmac_f32 v12, v46, v80
    v_fmac_f32 v13, v47, v81
    v_fmac_f32 v14, v48, v82
    v_fmac_f32 v15, v49, v83
    v_fmac_f32 v16, v50, v84
    v_fmac_f32 v17, v51, v85
    v_fmac_f32 v18, v52, v86
    v_fmac_f32 v19, v53, v87
    v_fmac_f32 v72, v72, v106
    v_fmac_f32 v73, v73, v107
    v_fmac_f32 v74, v74, v108
    v_fmac_f32 v75, v75, v109
    v_fmac_f32 v76, v76, v110
    v_fmac_f32 v77, v77, v111
    v_fmac_f32 v78, v78, v112
    v_fmac_f32 v79, v79, v113
    v_fmac_f32 v80, v80, v114
    v_fmac_f32 v81, v81, v115
    v_fmac_f32 v82, v82, v116
    v_fmac_f32 v83, v83, v117
    v_fmac_f32 v84, v84, v118
    v_fmac_f32 v85, v85, v119
    v_fmac_f32 v86, v86, v120
    v_fmac_f32 v87, v87, v121
    s_setprio 2
    v_exp_f32 v106, v54
    v_exp_f32 v107, v55
    v_exp_f32 v108, v56
    v_mfma_f32_32x32x8_bf16 v[38:53], v[180:181], v[184:185], v[124:139]
    v_exp_f32 v109, v57
    v_exp_f32 v110, v58
    v_exp_f32 v111, v59
    v_exp_f32 v112, v60
    v_exp_f32 v113, v61
    v_smfmac_f32_32x32x32_bf16 v[38:53], v[172:175], v[156:163], v176
    v_exp_f32 v114, v62
    v_exp_f32 v115, v63
    v_exp_f32 v116, v64
    v_exp_f32 v117, v65
    v_exp_f32 v118, v66
    v_exp_f32 v119, v67
    v_exp_f32 v120, v68
    v_exp_f32 v121, v69
    s_setprio 0
    s_cmp_lg_u64 s[76:77], 0
    s_cbranch_scc1 K_L15A
    s_mov_b64 exec, -1
    s_waitcnt vmcnt(0) lgkmcnt(0)
    ds_read_b128 v[156:159], v200 offset:32768
    ds_read_b128 v[160:163], v201 offset:32768
    ds_read_b64 v[186:187], v237 offset:24576
    s_mov_b64 exec, s[70:71]
    v_fmac_f32 v20, v20, v106
    v_fmac_f32 v21, v21, v107
    v_fmac_f32 v22, v22, v108
    v_fmac_f32 v23, v23, v109
    v_fmac_f32 v24, v24, v110
    v_fmac_f32 v25, v25, v111
    v_fmac_f32 v26, v26, v112
    v_fmac_f32 v27, v27, v113
    v_fmac_f32 v28, v28, v114
    v_fmac_f32 v29, v29, v115
    v_fmac_f32 v30, v30, v116
    v_fmac_f32 v31, v31, v117
    v_fmac_f32 v32, v32, v118
    v_fmac_f32 v33, v33, v119
    v_fmac_f32 v34, v34, v120
    v_fmac_f32 v35, v35, v121
    v_fmac_f32 v20, v54, v88
    v_fmac_f32 v21, v55, v89
    v_fmac_f32 v22, v56, v90
    v_fmac_f32 v23, v57, v91
    v_fmac_f32 v24, v58, v92
    v_fmac_f32 v25, v59, v93
    v_fmac_f32 v26, v60, v94
    v_fmac_f32 v27, v61, v95
    v_fmac_f32 v28, v62, v96
    v_fmac_f32 v29, v63, v97
    v_fmac_f32 v30, v64, v98
    v_fmac_f32 v31, v65, v99
    v_fmac_f32 v32, v66, v100
    v_fmac_f32 v33, v67, v101
    v_fmac_f32 v34, v68, v102
    v_fmac_f32 v35, v69, v103
    v_fmac_f32 v88, v88, v106
    v_fmac_f32 v89, v89, v107
    v_fmac_f32 v90, v90, v108
    v_fmac_f32 v91, v91, v109
    v_fmac_f32 v92, v92, v110
    v_fmac_f32 v93, v93, v111
    v_fmac_f32 v94, v94, v112
    v_fmac_f32 v95, v95, v113
    v_fmac_f32 v96, v96, v114
    v_fmac_f32 v97, v97, v115
    v_fmac_f32 v98, v98, v116
    v_fmac_f32 v99, v99, v117
    v_fmac_f32 v100, v100, v118
    v_fmac_f32 v101, v101, v119
    v_fmac_f32 v102, v102, v120
    v_fmac_f32 v103, v103, v121
    s_setprio 2
    v_exp_f32 v106, v38
    v_exp_f32 v107, v39
    v_exp_f32 v108, v40
    v_mfma_f32_32x32x8_bf16 v[54:69], v[182:183], v[184:185], v[140:155]
    v_exp_f32 v109, v41
    v_exp_f32 v110, v42
    v_exp_f32 v111, v43
    v_exp_f32 v112, v44
    v_exp_f32 v113, v45
    v_smfmac_f32_32x32x32_bf16 v[54:69], v[172:175], v[164:171], v176
    v_exp_f32 v114, v46
    v_exp_f32 v115, v47
    v_exp_f32 v116, v48
    v_exp_f32 v117, v49
    v_exp_f32 v118, v50
    v_exp_f32 v119, v51
    v_exp_f32 v120, v52
    v_exp_f32 v121, v53
    s_setprio 0
    s_mov_b64 exec, -1
    s_waitcnt lgkmcnt(0)
    ds_read_b128 v[164:167], v202 offset:32768
    ds_read_b128 v[168:171], v203 offset:32768
    s_mov_b64 exec, s[72:73]
    v_fmac_f32 v4, v4, v106
    v_fmac_f32 v5, v5, v107
    v_fmac_f32 v6, v6, v108
    v_fmac_f32 v7, v7, v109
    v_fmac_f32 v8, v8, v110
    v_fmac_f32 v9, v9, v111
    v_fmac_f32 v10, v10, v112
    v_fmac_f32 v11, v11, v113
    v_fmac_f32 v12, v12, v114
    v_fmac_f32 v13, v13, v115
    v_fmac_f32 v14, v14, v116
    v_fmac_f32 v15, v15, v117
    v_fmac_f32 v16, v16, v118
    v_fmac_f32 v17, v17, v119
    v_fmac_f32 v18, v18, v120
    v_fmac_f32 v19, v19, v121
    v_fmac_f32 v4, v38, v72
    v_fmac_f32 v5, v39, v73
    v_fmac_f32 v6, v40, v74
    v_fmac_f32 v7, v41, v75
    v_fmac_f32 v8, v42, v76
    v_fmac_f32 v9, v43, v77
    v_fmac_f32 v10, v44, v78
    v_fmac_f32 v11, v45, v79
    v_fmac_f32 v12, v46, v80
    v_fmac_f32 v13, v47, v81
    v_fmac_f32 v14, v48, v82
    v_fmac_f32 v15, v49, v83
    v_fmac_f32 v16, v50, v84
    v_fmac_f32 v17, v51, v85
    v_fmac_f32 v18, v52, v86
    v_fmac_f32 v19, v53, v87
    v_fmac_f32 v72, v72, v106
    v_fmac_f32 v73, v73, v107
    v_fmac_f32 v74, v74, v108
    v_fmac_f32 v75, v75, v109
    v_fmac_f32 v76, v76, v110
    v_fmac_f32 v77, v77, v111
    v_fmac_f32 v78, v78, v112
    v_fmac_f32 v79, v79, v113
    v_fmac_f32 v80, v80, v114
    v_fmac_f32 v81, v81, v115
    v_fmac_f32 v82, v82, v116
    v_fmac_f32 v83, v83, v117
    v_fmac_f32 v84, v84, v118
    v_fmac_f32 v85, v85, v119
    v_fmac_f32 v86, v86, v120
    v_fmac_f32 v87, v87, v121
    s_setprio 2
    v_exp_f32 v106, v54
    v_exp_f32 v107, v55
    v_exp_f32 v108, v56
    v_mfma_f32_32x32x8_bf16 v[38:53], v[180:181], v[186:187], v[124:139]
    v_exp_f32 v109, v57
    v_exp_f32 v110, v58
    v_exp_f32 v111, v59
    v_exp_f32 v112, v60
    v_exp_f32 v113, v61
    v_smfmac_f32_32x32x32_bf16 v[38:53], v[172:175], v[156:163], v176
    v_exp_f32 v114, v62
    v_exp_f32 v115, v63
    v_exp_f32 v116, v64
    v_exp_f32 v117, v65
    v_exp_f32 v118, v66
    v_exp_f32 v119, v67
    v_exp_f32 v120, v68
    v_exp_f32 v121, v69
    s_setprio 0
    s_mov_b64 exec, -1
    s_waitcnt vmcnt(0) lgkmcnt(0)
    s_mov_b64 exec, s[72:73]
    v_fmac_f32 v20, v20, v106
    v_fmac_f32 v21, v21, v107
    v_fmac_f32 v22, v22, v108
    v_fmac_f32 v23, v23, v109
    v_fmac_f32 v24, v24, v110
    v_fmac_f32 v25, v25, v111
    v_fmac_f32 v26, v26, v112
    v_fmac_f32 v27, v27, v113
    v_fmac_f32 v28, v28, v114
    v_fmac_f32 v29, v29, v115
    v_fmac_f32 v30, v30, v116
    v_fmac_f32 v31, v31, v117
    v_fmac_f32 v32, v32, v118
    v_fmac_f32 v33, v33, v119
    v_fmac_f32 v34, v34, v120
    v_fmac_f32 v35, v35, v121
    v_fmac_f32 v20, v54, v88
    v_fmac_f32 v21, v55, v89
    v_fmac_f32 v22, v56, v90
    v_fmac_f32 v23, v57, v91
    v_fmac_f32 v24, v58, v92
    v_fmac_f32 v25, v59, v93
    v_fmac_f32 v26, v60, v94
    v_fmac_f32 v27, v61, v95
    v_fmac_f32 v28, v62, v96
    v_fmac_f32 v29, v63, v97
    v_fmac_f32 v30, v64, v98
    v_fmac_f32 v31, v65, v99
    v_fmac_f32 v32, v66, v100
    v_fmac_f32 v33, v67, v101
    v_fmac_f32 v34, v68, v102
    v_fmac_f32 v35, v69, v103
    v_fmac_f32 v88, v88, v106
    v_fmac_f32 v89, v89, v107
    v_fmac_f32 v90, v90, v108
    v_fmac_f32 v91, v91, v109
    v_fmac_f32 v92, v92, v110
    v_fmac_f32 v93, v93, v111
    v_fmac_f32 v94, v94, v112
    v_fmac_f32 v95, v95, v113
    v_fmac_f32 v96, v96, v114
    v_fmac_f32 v97, v97, v115
    v_fmac_f32 v98, v98, v116
    v_fmac_f32 v99, v99, v117
    v_fmac_f32 v100, v100, v118
    v_fmac_f32 v101, v101, v119
    v_fmac_f32 v102, v102, v120
    v_fmac_f32 v103, v103, v121
    s_setprio 2
    v_exp_f32 v106, v38
    v_exp_f32 v107, v39
    v_exp_f32 v108, v40
    v_mfma_f32_32x32x8_bf16 v[54:69], v[182:183], v[186:187], v[140:155]
    v_exp_f32 v109, v41
    v_exp_f32 v110, v42
    v_exp_f32 v111, v43
    v_exp_f32 v112, v44
    v_exp_f32 v113, v45
    v_smfmac_f32_32x32x32_bf16 v[54:69], v[172:175], v[164:171], v176
    v_exp_f32 v114, v46
    v_exp_f32 v115, v47
    v_exp_f32 v116, v48
    v_exp_f32 v117, v49
    v_exp_f32 v118, v50
    v_exp_f32 v119, v51
    v_exp_f32 v120, v52
    v_exp_f32 v121, v53
    s_setprio 0
    s_mov_b64 exec, -1
    s_mov_b64 exec, s[74:75]
    v_fmac_f32 v4, v4, v106
    v_fmac_f32 v5, v5, v107
    v_fmac_f32 v6, v6, v108
    v_fmac_f32 v7, v7, v109
    v_fmac_f32 v8, v8, v110
    v_fmac_f32 v9, v9, v111
    v_fmac_f32 v10, v10, v112
    v_fmac_f32 v11, v11, v113
    v_fmac_f32 v12, v12, v114
    v_fmac_f32 v13, v13, v115
    v_fmac_f32 v14, v14, v116
    v_fmac_f32 v15, v15, v117
    v_fmac_f32 v16, v16, v118
    v_fmac_f32 v17, v17, v119
    v_fmac_f32 v18, v18, v120
    v_fmac_f32 v19, v19, v121
    v_fmac_f32 v4, v38, v72
    v_fmac_f32 v5, v39, v73
    v_fmac_f32 v6, v40, v74
    v_fmac_f32 v7, v41, v75
    v_fmac_f32 v8, v42, v76
    v_fmac_f32 v9, v43, v77
    v_fmac_f32 v10, v44, v78
    v_fmac_f32 v11, v45, v79
    v_fmac_f32 v12, v46, v80
    v_fmac_f32 v13, v47, v81
    v_fmac_f32 v14, v48, v82
    v_fmac_f32 v15, v49, v83
    v_fmac_f32 v16, v50, v84
    v_fmac_f32 v17, v51, v85
    v_fmac_f32 v18, v52, v86
    v_fmac_f32 v19, v53, v87
    v_fmac_f32 v72, v72, v106
    v_fmac_f32 v73, v73, v107
    v_fmac_f32 v74, v74, v108
    v_fmac_f32 v75, v75, v109
    v_fmac_f32 v76, v76, v110
    v_fmac_f32 v77, v77, v111
    v_fmac_f32 v78, v78, v112
    v_fmac_f32 v79, v79, v113
    v_fmac_f32 v80, v80, v114
    v_fmac_f32 v81, v81, v115
    v_fmac_f32 v82, v82, v116
    v_fmac_f32 v83, v83, v117
    v_fmac_f32 v84, v84, v118
    v_fmac_f32 v85, v85, v119
    v_fmac_f32 v86, v86, v120
    v_fmac_f32 v87, v87, v121
    s_mov_b64 exec, -1
    v_mul_f32 v38, v72, v73
    v_mul_f32 v39, v74, v75
    v_mul_f32 v40, v76, v77
    v_mul_f32 v41, v78, v79
    v_mul_f32 v42, v80, v81
    v_mul_f32 v43, v82, v83
    v_mul_f32 v44, v84, v85
    v_mul_f32 v45, v86, v87
    v_mul_f32 v4, v4, v73
    v_mul_f32 v5, v5, v72
    v_mul_f32 v6, v6, v75
    v_mul_f32 v7, v7, v74
    v_mul_f32 v8, v8, v77
    v_mul_f32 v9, v9, v76
    v_mul_f32 v10, v10, v79
    v_mul_f32 v11, v11, v78
    v_mul_f32 v12, v12, v81
    v_mul_f32 v13, v13, v80
    v_mul_f32 v14, v14, v83
    v_mul_f32 v15, v15, v82
    v_mul_f32 v16, v16, v85
    v_mul_f32 v17, v17, v84
    v_mul_f32 v18, v18, v87
    v_mul_f32 v19, v19, v86
    v_add_f32 v250, v250, v38
    v_add_f32 v250, v250, v39
    v_add_f32 v250, v250, v40
    v_add_f32 v250, v250, v41
    v_add_f32 v250, v250, v42
    v_add_f32 v250, v250, v43
    v_add_f32 v250, v250, v44
    v_add_f32 v250, v250, v45
    s_setprio 2
    v_rcp_f32 v38, v38
    v_rcp_f32 v39, v39
    v_rcp_f32 v40, v40
    v_rcp_f32 v41, v41
    v_rcp_f32 v42, v42
    v_rcp_f32 v43, v43
    v_rcp_f32 v44, v44
    v_rcp_f32 v45, v45
    v_exp_f32 v106, v54
    v_exp_f32 v107, v55
    v_exp_f32 v108, v56
    v_exp_f32 v109, v57
    v_exp_f32 v110, v58
    v_exp_f32 v111, v59
    v_exp_f32 v112, v60
    v_exp_f32 v113, v61
    v_exp_f32 v114, v62
    v_exp_f32 v115, v63
    v_exp_f32 v116, v64
    v_exp_f32 v117, v65
    v_exp_f32 v118, v66
    v_exp_f32 v119, v67
    v_exp_f32 v120, v68
    v_exp_f32 v121, v69
    s_setprio 0
    ds_read_b64_tr_b16 v[124:125], v246 offset:0
    ds_read_b64_tr_b16 v[126:127], v246 offset:512
    ds_read_b64_tr_b16 v[128:129], v246 offset:4096
    ds_read_b64_tr_b16 v[130:131], v246 offset:4608
    ds_read_b64_tr_b16 v[132:133], v246 offset:8
    ds_read_b64_tr_b16 v[134:135], v246 offset:520
    ds_read_b64_tr_b16 v[136:137], v246 offset:4104
    ds_read_b64_tr_b16 v[138:139], v246 offset:4616
    ds_read_b64_tr_b16 v[140:141], v177 offset:0
    ds_read_b64_tr_b16 v[142:143], v177 offset:512
    ds_read_b64_tr_b16 v[144:145], v177 offset:4096
    ds_read_b64_tr_b16 v[146:147], v177 offset:4608
    ds_read_b64_tr_b16 v[148:149], v177 offset:8
    ds_read_b64_tr_b16 v[150:151], v177 offset:520
    ds_read_b64_tr_b16 v[152:153], v177 offset:4104
    ds_read_b64_tr_b16 v[154:155], v177 offset:4616
    v_mul_f32 v4, v4, v38
    v_mul_f32 v5, v5, v38
    v_mul_f32 v6, v6, v39
    v_mul_f32 v7, v7, v39
    v_mul_f32 v8, v8, v40
    v_mul_f32 v9, v9, v40
    v_mul_f32 v10, v10, v41
    v_mul_f32 v11, v11, v41
    v_mul_f32 v12, v12, v42
    v_mul_f32 v13, v13, v42
    v_mul_f32 v14, v14, v43
    v_mul_f32 v15, v15, v43
    v_mul_f32 v16, v16, v44
    v_mul_f32 v17, v17, v44
    v_mul_f32 v18, v18, v45
    v_mul_f32 v19, v19, v45
    s_mov_b64 exec, s[74:75]
    v_fmac_f32 v20, v20, v106
    v_fmac_f32 v21, v21, v107
    v_fmac_f32 v22, v22, v108
    v_fmac_f32 v23, v23, v109
    v_fmac_f32 v24, v24, v110
    v_fmac_f32 v25, v25, v111
    v_fmac_f32 v26, v26, v112
    v_fmac_f32 v27, v27, v113
    v_fmac_f32 v28, v28, v114
    v_fmac_f32 v29, v29, v115
    v_fmac_f32 v30, v30, v116
    v_fmac_f32 v31, v31, v117
    v_fmac_f32 v32, v32, v118
    v_fmac_f32 v33, v33, v119
    v_fmac_f32 v34, v34, v120
    v_fmac_f32 v35, v35, v121
    v_fmac_f32 v20, v54, v88
    v_fmac_f32 v21, v55, v89
    v_fmac_f32 v22, v56, v90
    v_fmac_f32 v23, v57, v91
    v_fmac_f32 v24, v58, v92
    v_fmac_f32 v25, v59, v93
    v_fmac_f32 v26, v60, v94
    v_fmac_f32 v27, v61, v95
    v_fmac_f32 v28, v62, v96
    v_fmac_f32 v29, v63, v97
    v_fmac_f32 v30, v64, v98
    v_fmac_f32 v31, v65, v99
    v_fmac_f32 v32, v66, v100
    v_fmac_f32 v33, v67, v101
    v_fmac_f32 v34, v68, v102
    v_fmac_f32 v35, v69, v103
    v_fmac_f32 v88, v88, v106
    v_fmac_f32 v89, v89, v107
    v_fmac_f32 v90, v90, v108
    v_fmac_f32 v91, v91, v109
    v_fmac_f32 v92, v92, v110
    v_fmac_f32 v93, v93, v111
    v_fmac_f32 v94, v94, v112
    v_fmac_f32 v95, v95, v113
    v_fmac_f32 v96, v96, v114
    v_fmac_f32 v97, v97, v115
    v_fmac_f32 v98, v98, v116
    v_fmac_f32 v99, v99, v117
    v_fmac_f32 v100, v100, v118
    v_fmac_f32 v101, v101, v119
    v_fmac_f32 v102, v102, v120
    v_fmac_f32 v103, v103, v121
    s_mov_b64 exec, -1
    v_mul_f32 v54, v88, v89
    v_mul_f32 v55, v90, v91
    v_mul_f32 v56, v92, v93
    v_mul_f32 v57, v94, v95
    v_mul_f32 v58, v96, v97
    v_mul_f32 v59, v98, v99
    v_mul_f32 v60, v100, v101
    v_mul_f32 v61, v102, v103
    v_mul_f32 v20, v20, v89
    v_mul_f32 v21, v21, v88
    v_mul_f32 v22, v22, v91
    v_mul_f32 v23, v23, v90
    v_mul_f32 v24, v24, v93
    v_mul_f32 v25, v25, v92
    v_mul_f32 v26, v26, v95
    v_mul_f32 v27, v27, v94
    v_mul_f32 v28, v28, v97
    v_mul_f32 v29, v29, v96
    v_mul_f32 v30, v30, v99
    v_mul_f32 v31, v31, v98
    v_mul_f32 v32, v32, v101
    v_mul_f32 v33, v33, v100
    v_mul_f32 v34, v34, v103
    v_mul_f32 v35, v35, v102
    v_add_f32 v250, v250, v54
    v_add_f32 v250, v250, v55
    v_add_f32 v250, v250, v56
    v_add_f32 v250, v250, v57
    v_add_f32 v250, v250, v58
    v_add_f32 v250, v250, v59
    v_add_f32 v250, v250, v60
    v_add_f32 v250, v250, v61
    s_setprio 2
    v_rcp_f32 v54, v54
    v_rcp_f32 v55, v55
    v_rcp_f32 v56, v56
    v_rcp_f32 v57, v57
    v_rcp_f32 v58, v58
    v_rcp_f32 v59, v59
    v_rcp_f32 v60, v60
    v_rcp_f32 v61, v61
    v_cvt_pk_bf16_f32 v46, v4, v5
    v_cvt_pk_bf16_f32 v47, v6, v7
    v_cvt_pk_bf16_f32 v48, v8, v9
    v_cvt_pk_bf16_f32 v49, v10, v11
    ds_write_b128 v238, v[46:49]
    v_cvt_pk_bf16_f32 v50, v12, v13
    v_cvt_pk_bf16_f32 v51, v14, v15
    v_cvt_pk_bf16_f32 v52, v16, v17
    v_cvt_pk_bf16_f32 v53, v18, v19
    ds_write_b128 v239, v[50:53]
    s_setprio 0
    v_mul_f32 v20, v20, v54
    v_mul_f32 v21, v21, v54
    v_mul_f32 v22, v22, v55
    v_mul_f32 v23, v23, v55
    v_mul_f32 v24, v24, v56
    v_mul_f32 v25, v25, v56
    v_mul_f32 v26, v26, v57
    v_mul_f32 v27, v27, v57
    v_mul_f32 v28, v28, v58
    v_mul_f32 v29, v29, v58
    v_mul_f32 v30, v30, v59
    v_mul_f32 v31, v31, v59
    v_mul_f32 v32, v32, v60
    v_mul_f32 v33, v33, v60
    v_mul_f32 v34, v34, v61
    v_mul_f32 v35, v35, v61
    v_cmp_ngt_f32 vcc, 0x6c800000, v250
    v_cvt_pk_bf16_f32 v62, v20, v21
    v_cvt_pk_bf16_f32 v63, v22, v23
    v_cvt_pk_bf16_f32 v64, v24, v25
    v_cvt_pk_bf16_f32 v65, v26, v27
    ds_write_b128 v240, v[62:65]
    v_cvt_pk_bf16_f32 v66, v28, v29
    v_cvt_pk_bf16_f32 v67, v30, v31
    v_cvt_pk_bf16_f32 v68, v32, v33
    v_cvt_pk_bf16_f32 v69, v34, v35
    ds_write_b128 v241, v[66:69]
    s_branch K_FLUSHED
.p2align 12
K_STB0:
    s_setpc_b64 s[0:1]
K_MAINB:
    s_waitcnt lgkmcnt(0)
    s_mov_b32 m0, s86
    ds_read_b64 v[186:187], v237 offset:24576
    buffer_load_dwordx4 v[188:189], s[28:31], 0 idxen offen offset:0 sc1 lds
    buffer_load_dwordx4 v[190:191], s[28:31], 0 idxen offen offset:1024 sc1 lds
    buffer_load_dwordx4 v[192:193], s[28:31], 0 idxen offen offset:2048 sc1 lds
    buffer_load_dwordx4 v[194:195], s[28:31], 0 idxen offen offset:3072 sc1 lds
    s_nop 2
    s_setprio 1
    v_exp_f32 v72, v4
    v_exp_f32 v73, v5
    v_exp_f32 v74, v6
    v_mfma_f32_32x32x8_bf16 v[20:35], v[182:183], v[184:185], v[140:155]
    v_exp_f32 v75, v7
    v_exp_f32 v76, v8
    v_exp_f32 v77, v9
    v_exp_f32 v78, v10
    v_exp_f32 v79, v11
    v_smfmac_f32_32x32x32_bf16 v[20:35], v[172:175], v[164:171], v176
    v_exp_f32 v80, v12
    v_exp_f32 v81, v13
    v_exp_f32 v82, v14
    v_exp_f32 v83, v15
    v_exp_f32 v84, v16
    v_exp_f32 v85, v17
    v_exp_f32 v86, v18
    v_exp_f32 v87, v19
    s_setprio 3
    v_add_f32 v72, 1.0, v72
    v_add_f32 v73, 1.0, v73
    v_add_f32 v74, 1.0, v74
    v_add_f32 v75, 1.0, v75
    v_add_f32 v76, 1.0, v76
    v_add_f32 v77, 1.0, v77
    v_add_f32 v78, 1.0, v78
    v_add_f32 v79, 1.0, v79
    v_add_f32 v80, 1.0, v80
    v_add_f32 v81, 1.0, v81
    v_add_f32 v82, 1.0, v82
    v_add_f32 v83, 1.0, v83
    v_add_f32 v84, 1.0, v84
    v_add_f32 v85, 1.0, v85
    v_add_f32 v86, 1.0, v86
    v_add_f32 v87, 1.0, v87
    s_waitcnt vmcnt(4)
    ds_read_b128 v[156:159], v200 offset:32768
    ds_read_b128 v[160:163], v201 offset:32768
    ds_read_b128 v[164:167], v202 offset:32768
    ds_read_b128 v[168:171], v203 offset:32768
    ds_read_u16 v188, v196 offset:12
    ds_read_u16 v190, v197 offset:12
    ds_read_u16 v192, v198 offset:12
    ds_read_u16 v194, v199 offset:12
    ds_read_u16 v237, v236 offset:10
    s_waitcnt lgkmcnt(7)
    s_setprio 1
    v_exp_f32 v88, v20
    v_exp_f32 v89, v21
    v_exp_f32 v90, v22
    v_mfma_f32_32x32x8_bf16 v[38:53], v[180:181], v[186:187], v[124:139]
    v_exp_f32 v91, v23
    v_exp_f32 v92, v24
    v_exp_f32 v93, v25
    v_exp_f32 v94, v26
    v_exp_f32 v95, v27
    v_smfmac_f32_32x32x32_bf16 v[38:53], v[172:175], v[156:163], v176
    v_exp_f32 v96, v28
    v_exp_f32 v97, v29
    v_exp_f32 v98, v30
    v_exp_f32 v99, v31
    v_exp_f32 v100, v32
    v_exp_f32 v101, v33
    v_exp_f32 v102, v34
    v_exp_f32 v103, v35
    s_setprio 3
    v_add_f32 v88, 1.0, v88
    v_add_f32 v89, 1.0, v89
    v_add_f32 v90, 1.0, v90
    v_add_f32 v91, 1.0, v91
    v_add_f32 v92, 1.0, v92
    v_add_f32 v93, 1.0, v93
    v_add_f32 v94, 1.0, v94
    v_add_f32 v95, 1.0, v95
    v_add_f32 v96, 1.0, v96
    v_add_f32 v97, 1.0, v97
    v_add_f32 v98, 1.0, v98
    v_add_f32 v99, 1.0, v99
    v_add_f32 v100, 1.0, v100
    v_add_f32 v101, 1.0, v101
    v_add_f32 v102, 1.0, v102
    v_add_f32 v103, 1.0, v103
    s_mov_b64 exec, -1
    s_waitcnt vmcnt(0) lgkmcnt(0)
    s_add_u32 m0, s86, 32768
    ds_read_b128 v[156:159], v200 offset:0
    ds_read_b128 v[160:163], v201 offset:0
    ds_read_b64 v[184:185], v237 offset:24576
    buffer_load_dwordx4 v[188:189], s[28:31], 0 idxen offen offset:0 sc1 lds
    buffer_load_dwordx4 v[190:191], s[28:31], 0 idxen offen offset:1024 sc1 lds
    buffer_load_dwordx4 v[192:193], s[28:31], 0 idxen offen offset:2048 sc1 lds
    buffer_load_dwordx4 v[194:195], s[28:31], 0 idxen offen offset:3072 sc1 lds
    s_mov_b64 exec, s[50:51]
    s_setprio 1
    v_exp_f32 v106, v38
    v_exp_f32 v107, v39
    v_exp_f32 v108, v40
    v_mfma_f32_32x32x8_bf16 v[54:69], v[182:183], v[186:187], v[140:155]
    v_exp_f32 v109, v41
    v_exp_f32 v110, v42
    v_exp_f32 v111, v43
    v_exp_f32 v112, v44
    v_exp_f32 v113, v45
    v_smfmac_f32_32x32x32_bf16 v[54:69], v[172:175], v[164:171], v176
    v_exp_f32 v114, v46
    v_exp_f32 v115, v47
    v_exp_f32 v116, v48
    v_exp_f32 v117, v49
    v_exp_f32 v118, v50
    v_exp_f32 v119, v51
    v_exp_f32 v120, v52
    v_exp_f32 v121, v53
    s_setprio 3
    v_fmac_f32 v4, v4, v106
    v_fmac_f32 v5, v5, v107
    v_fmac_f32 v6, v6, v108
    v_fmac_f32 v7, v7, v109
    v_fmac_f32 v8, v8, v110
    v_fmac_f32 v9, v9, v111
    v_fmac_f32 v10, v10, v112
    v_fmac_f32 v11, v11, v113
    v_fmac_f32 v12, v12, v114
    v_fmac_f32 v13, v13, v115
    v_fmac_f32 v14, v14, v116
    v_fmac_f32 v15, v15, v117
    v_fmac_f32 v16, v16, v118
    v_fmac_f32 v17, v17, v119
    v_fmac_f32 v18, v18, v120
    v_fmac_f32 v19, v19, v121
    v_fmac_f32 v4, v38, v72
    v_fmac_f32 v5, v39, v73
    v_fmac_f32 v6, v40, v74
    v_fmac_f32 v7, v41, v75
    v_fmac_f32 v8, v42, v76
    v_fmac_f32 v9, v43, v77
    v_fmac_f32 v10, v44, v78
    v_fmac_f32 v11, v45, v79
    v_fmac_f32 v12, v46, v80
    v_fmac_f32 v13, v47, v81
    v_fmac_f32 v14, v48, v82
    v_fmac_f32 v15, v49, v83
    v_fmac_f32 v16, v50, v84
    v_fmac_f32 v17, v51, v85
    v_fmac_f32 v18, v52, v86
    v_fmac_f32 v19, v53, v87
    v_fmac_f32 v72, v72, v106
    v_fmac_f32 v73, v73, v107
    v_fmac_f32 v74, v74, v108
    v_fmac_f32 v75, v75, v109
    v_fmac_f32 v76, v76, v110
    v_fmac_f32 v77, v77, v111
    v_fmac_f32 v78, v78, v112
    v_fmac_f32 v79, v79, v113
    v_fmac_f32 v80, v80, v114
    v_fmac_f32 v81, v81, v115
    v_fmac_f32 v82, v82, v116
    v_fmac_f32 v83, v83, v117
    v_fmac_f32 v84, v84, v118
    v_fmac_f32 v85, v85, v119
    v_fmac_f32 v86, v86, v120
    v_fmac_f32 v87, v87, v121
    s_mov_b64 exec, -1
    s_waitcnt lgkmcnt(0)
    ds_read_b128 v[164:167], v202 offset:0
    ds_read_b128 v[168:171], v203 offset:0
    ds_read_u16 v188, v196 offset:16
    ds_read_u16 v190, v197 offset:16
    ds_read_u16 v192, v198 offset:16
    ds_read_u16 v194, v199 offset:16
    ds_read_u16 v237, v236 offset:14
    s_mov_b64 exec, s[50:51]
    s_setprio 1
    v_exp_f32 v106, v54
    v_exp_f32 v107, v55
    v_exp_f32 v108, v56
    v_mfma_f32_32x32x8_bf16 v[38:53], v[180:181], v[184:185], v[124:139]
    v_exp_f32 v109, v57
    v_exp_f32 v110, v58
    v_exp_f32 v111, v59
    v_exp_f32 v112, v60
    v_exp_f32 v113, v61
    v_smfmac_f32_32x32x32_bf16 v[38:53], v[172:175], v[156:163], v176
    v_exp_f32 v114, v62
    v_exp_f32 v115, v63
    v_exp_f32 v116, v64
    v_exp_f32 v117, v65
    v_exp_f32 v118, v66
    v_exp_f32 v119, v67
    v_exp_f32 v120, v68
    v_exp_f32 v121, v69
    s_setprio 3
    v_fmac_f32 v20, v20, v106
    v_fmac_f32 v21, v21, v107
    v_fmac_f32 v22, v22, v108
    v_fmac_f32 v23, v23, v109
    v_fmac_f32 v24, v24, v110
    v_fmac_f32 v25, v25, v111
    v_fmac_f32 v26, v26, v112
    v_fmac_f32 v27, v27, v113
    v_fmac_f32 v28, v28, v114
    v_fmac_f32 v29, v29, v115
    v_fmac_f32 v30, v30, v116
    v_fmac_f32 v31, v31, v117
    v_fmac_f32 v32, v32, v118
    v_fmac_f32 v33, v33, v119
    v_fmac_f32 v34, v34, v120
    v_fmac_f32 v35, v35, v121
    v_fmac_f32 v20, v54, v88
    v_fmac_f32 v21, v55, v89
    v_fmac_f32 v22, v56, v90
    v_fmac_f32 v23, v57, v91
    v_fmac_f32 v24, v58, v92
    v_fmac_f32 v25, v59, v93
    v_fmac_f32 v26, v60, v94
    v_fmac_f32 v27, v61, v95
    v_fmac_f32 v28, v62, v96
    v_fmac_f32 v29, v63, v97
    v_fmac_f32 v30, v64, v98
    v_fmac_f32 v31, v65, v99
    v_fmac_f32 v32, v66, v100
    v_fmac_f32 v33, v67, v101
    v_fmac_f32 v34, v68, v102
    v_fmac_f32 v35, v69, v103
    v_fmac_f32 v88, v88, v106
    v_fmac_f32 v89, v89, v107
    v_fmac_f32 v90, v90, v108
    v_fmac_f32 v91, v91, v109
    v_fmac_f32 v92, v92, v110
    v_fmac_f32 v93, v93, v111
    v_fmac_f32 v94, v94, v112
    v_fmac_f32 v95, v95, v113
    v_fmac_f32 v96, v96, v114
    v_fmac_f32 v97, v97, v115
    v_fmac_f32 v98, v98, v116
    v_fmac_f32 v99, v99, v117
    v_fmac_f32 v100, v100, v118
    v_fmac_f32 v101, v101, v119
    v_fmac_f32 v102, v102, v120
    v_fmac_f32 v103, v103, v121
    s_mov_b64 exec, -1
    s_waitcnt vmcnt(0) lgkmcnt(0)
    s_add_u32 m0, s86, 0
    ds_read_b128 v[156:159], v200 offset:32768
    ds_read_b128 v[160:163], v201 offset:32768
    ds_read_b64 v[186:187], v237 offset:24576
    buffer_load_dwordx4 v[188:189], s[28:31], 0 idxen offen offset:0 sc1 lds
    buffer_load_dwordx4 v[190:191], s[28:31], 0 idxen offen offset:1024 sc1 lds
    buffer_load_dwordx4 v[192:193], s[28:31], 0 idxen offen offset:2048 sc1 lds
    buffer_load_dwordx4 v[194:195], s[28:31], 0 idxen offen offset:3072 sc1 lds
    s_mov_b64 exec, s[52:53]
    s_setprio 1
    v_exp_f32 v106, v38
    v_exp_f32 v107, v39
    v_exp_f32 v108, v40
    v_mfma_f32_32x32x8_bf16 v[54:69], v[182:183], v[184:185], v[140:155]
    v_exp_f32 v109, v41
    v_exp_f32 v110, v42
    v_exp_f32 v111, v43
    v_exp_f32 v112, v44
    v_exp_f32 v113, v45
    v_smfmac_f32_32x32x32_bf16 v[54:69], v[172:175], v[164:171], v176
    v_exp_f32 v114, v46
    v_exp_f32 v115, v47
    v_exp_f32 v116, v48
    v_exp_f32 v117, v49
    v_exp_f32 v118, v50
    v_exp_f32 v119, v51
    v_exp_f32 v120, v52
    v_exp_f32 v121, v53
    s_setprio 3
    v_fmac_f32 v4, v4, v106
    v_fmac_f32 v5, v5, v107
    v_fmac_f32 v6, v6, v108
    v_fmac_f32 v7, v7, v109
    v_fmac_f32 v8, v8, v110
    v_fmac_f32 v9, v9, v111
    v_fmac_f32 v10, v10, v112
    v_fmac_f32 v11, v11, v113
    v_fmac_f32 v12, v12, v114
    v_fmac_f32 v13, v13, v115
    v_fmac_f32 v14, v14, v116
    v_fmac_f32 v15, v15, v117
    v_fmac_f32 v16, v16, v118
    v_fmac_f32 v17, v17, v119
    v_fmac_f32 v18, v18, v120
    v_fmac_f32 v19, v19, v121
    v_fmac_f32 v4, v38, v72
    v_fmac_f32 v5, v39, v73
    v_fmac_f32 v6, v40, v74
    v_fmac_f32 v7, v41, v75
    v_fmac_f32 v8, v42, v76
    v_fmac_f32 v9, v43, v77
    v_fmac_f32 v10, v44, v78
    v_fmac_f32 v11, v45, v79
    v_fmac_f32 v12, v46, v80
    v_fmac_f32 v13, v47, v81
    v_fmac_f32 v14, v48, v82
    v_fmac_f32 v15, v49, v83
    v_fmac_f32 v16, v50, v84
    v_fmac_f32 v17, v51, v85
    v_fmac_f32 v18, v52, v86
    v_fmac_f32 v19, v53, v87
    v_fmac_f32 v72, v72, v106
    v_fmac_f32 v73, v73, v107
    v_fmac_f32 v74, v74, v108
    v_fmac_f32 v75, v75, v109
    v_fmac_f32 v76, v76, v110
    v_fmac_f32 v77, v77, v111
    v_fmac_f32 v78, v78, v112
    v_fmac_f32 v79, v79, v113
    v_fmac_f32 v80, v80, v114
    v_fmac_f32 v81, v81, v115
    v_fmac_f32 v82, v82, v116
    v_fmac_f32 v83, v83, v117
    v_fmac_f32 v84, v84, v118
    v_fmac_f32 v85, v85, v119
    v_fmac_f32 v86, v86, v120
    v_fmac_f32 v87, v87, v121
    s_mov_b64 exec, -1
    s_waitcnt lgkmcnt(0)
    ds_read_b128 v[164:167], v202 offset:32768
    ds_read_b128 v[168:171], v203 offset:32768
    ds_read_u16 v188, v196 offset:20
    ds_read_u16 v190, v197 offset:20
    ds_read_u16 v192, v198 offset:20
    ds_read_u16 v194, v199 offset:20
    ds_read_u16 v237, v236 offset:18
    s_mov_b64 exec, s[52:53]
    s_setprio 1
    v_exp_f32 v106, v54
    v_exp_f32 v107, v55
    v_exp_f32 v108, v56
    v_mfma_f32_32x32x8_bf16 v[38:53], v[180:181], v[186:187], v[124:139]
    v_exp_f32 v109, v57
    v_exp_f32 v110, v58
    v_exp_f32 v111, v59
    v_exp_f32 v112, v60
    v_exp_f32 v113, v61
    v_smfmac_f32_32x32x32_bf16 v[38:53], v[172:175], v[156:163], v176
    v_exp_f32 v114, v62
    v_exp_f32 v115, v63
    v_exp_f32 v116, v64
    v_exp_f32 v117, v65
    v_exp_f32 v118, v66
    v_exp_f32 v119, v67
    v_exp_f32 v120, v68
    v_exp_f32 v121, v69
    s_setprio 3
    v_fmac_f32 v20, v20, v106
    v_fmac_f32 v21, v21, v107
    v_fmac_f32 v22, v22, v108
    v_fmac_f32 v23, v23, v109
    v_fmac_f32 v24, v24, v110
    v_fmac_f32 v25, v25, v111
    v_fmac_f32 v26, v26, v112
    v_fmac_f32 v27, v27, v113
    v_fmac_f32 v28, v28, v114
    v_fmac_f32 v29, v29, v115
    v_fmac_f32 v30, v30, v116
    v_fmac_f32 v31, v31, v117
    v_fmac_f32 v32, v32, v118
    v_fmac_f32 v33, v33, v119
    v_fmac_f32 v34, v34, v120
    v_fmac_f32 v35, v35, v121
    v_fmac_f32 v20, v54, v88
    v_fmac_f32 v21, v55, v89
    v_fmac_f32 v22, v56, v90
    v_fmac_f32 v23, v57, v91
    v_fmac_f32 v24, v58, v92
    v_fmac_f32 v25, v59, v93
    v_fmac_f32 v26, v60, v94
    v_fmac_f32 v27, v61, v95
    v_fmac_f32 v28, v62, v96
    v_fmac_f32 v29, v63, v97
    v_fmac_f32 v30, v64, v98
    v_fmac_f32 v31, v65, v99
    v_fmac_f32 v32, v66, v100
    v_fmac_f32 v33, v67, v101
    v_fmac_f32 v34, v68, v102
    v_fmac_f32 v35, v69, v103
    v_fmac_f32 v88, v88, v106
    v_fmac_f32 v89, v89, v107
    v_fmac_f32 v90, v90, v108
    v_fmac_f32 v91, v91, v109
    v_fmac_f32 v92, v92, v110
    v_fmac_f32 v93, v93, v111
    v_fmac_f32 v94, v94, v112
    v_fmac_f32 v95, v95, v113
    v_fmac_f32 v96, v96, v114
    v_fmac_f32 v97, v97, v115
    v_fmac_f32 v98, v98, v116
    v_fmac_f32 v99, v99, v117
    v_fmac_f32 v100, v100, v118
    v_fmac_f32 v101, v101, v119
    v_fmac_f32 v102, v102, v120
    v_fmac_f32 v103, v103, v121
    s_mov_b64 exec, -1
    s_waitcnt vmcnt(0) lgkmcnt(0)
    s_add_u32 m0, s86, 32768
    ds_read_b128 v[156:159], v200 offset:0
    ds_read_b128 v[160:163], v201 offset:0
    ds_read_b64 v[184:185], v237 offset:24576
    buffer_load_dwordx4 v[188:189], s[28:31], 0 idxen offen offset:0 sc1 lds
    buffer_load_dwordx4 v[190:191], s[28:31], 0 idxen offen offset:1024 sc1 lds
    buffer_load_dwordx4 v[192:193], s[28:31], 0 idxen offen offset:2048 sc1 lds
    buffer_load_dwordx4 v[194:195], s[28:31], 0 idxen offen offset:3072 sc1 lds
    s_mov_b64 exec, s[54:55]
    s_setprio 1
    v_exp_f32 v106, v38
    v_exp_f32 v107, v39
    v_exp_f32 v108, v40
    v_mfma_f32_32x32x8_bf16 v[54:69], v[182:183], v[186:187], v[140:155]
    v_exp_f32 v109, v41
    v_exp_f32 v110, v42
    v_exp_f32 v111, v43
    v_exp_f32 v112, v44
    v_exp_f32 v113, v45
    v_smfmac_f32_32x32x32_bf16 v[54:69], v[172:175], v[164:171], v176
    v_exp_f32 v114, v46
    v_exp_f32 v115, v47
    v_exp_f32 v116, v48
    v_exp_f32 v117, v49
    v_exp_f32 v118, v50
    v_exp_f32 v119, v51
    v_exp_f32 v120, v52
    v_exp_f32 v121, v53
    s_setprio 3
    v_fmac_f32 v4, v4, v106
    v_fmac_f32 v5, v5, v107
    v_fmac_f32 v6, v6, v108
    v_fmac_f32 v7, v7, v109
    v_fmac_f32 v8, v8, v110
    v_fmac_f32 v9, v9, v111
    v_fmac_f32 v10, v10, v112
    v_fmac_f32 v11, v11, v113
    v_fmac_f32 v12, v12, v114
    v_fmac_f32 v13, v13, v115
    v_fmac_f32 v14, v14, v116
    v_fmac_f32 v15, v15, v117
    v_fmac_f32 v16, v16, v118
    v_fmac_f32 v17, v17, v119
    v_fmac_f32 v18, v18, v120
    v_fmac_f32 v19, v19, v121
    v_fmac_f32 v4, v38, v72
    v_fmac_f32 v5, v39, v73
    v_fmac_f32 v6, v40, v74
    v_fmac_f32 v7, v41, v75
    v_fmac_f32 v8, v42, v76
    v_fmac_f32 v9, v43, v77
    v_fmac_f32 v10, v44, v78
    v_fmac_f32 v11, v45, v79
    v_fmac_f32 v12, v46, v80
    v_fmac_f32 v13, v47, v81
    v_fmac_f32 v14, v48, v82
    v_fmac_f32 v15, v49, v83
    v_fmac_f32 v16, v50, v84
    v_fmac_f32 v17, v51, v85
    v_fmac_f32 v18, v52, v86
    v_fmac_f32 v19, v53, v87
    v_fmac_f32 v72, v72, v106
    v_fmac_f32 v73, v73, v107
    v_fmac_f32 v74, v74, v108
    v_fmac_f32 v75, v75, v109
    v_fmac_f32 v76, v76, v110
    v_fmac_f32 v77, v77, v111
    v_fmac_f32 v78, v78, v112
    v_fmac_f32 v79, v79, v113
    v_fmac_f32 v80, v80, v114
    v_fmac_f32 v81, v81, v115
    v_fmac_f32 v82, v82, v116
    v_fmac_f32 v83, v83, v117
    v_fmac_f32 v84, v84, v118
    v_fmac_f32 v85, v85, v119
    v_fmac_f32 v86, v86, v120
    v_fmac_f32 v87, v87, v121
    s_mov_b64 exec, -1
    s_waitcnt lgkmcnt(0)
    ds_read_b128 v[164:167], v202 offset:0
    ds_read_b128 v[168:171], v203 offset:0
    ds_read_u16 v188, v196 offset:24
    ds_read_u16 v190, v197 offset:24
    ds_read_u16 v192, v198 offset:24
    ds_read_u16 v194, v199 offset:24
    ds_read_u16 v237, v236 offset:22
    s_mov_b64 exec, s[54:55]
    s_setprio 1
    v_exp_f32 v106, v54
    v_exp_f32 v107, v55
    v_exp_f32 v108, v56
    v_mfma_f32_32x32x8_bf16 v[38:53], v[180:181], v[184:185], v[124:139]
    v_exp_f32 v109, v57
    v_exp_f32 v110, v58
    v_exp_f32 v111, v59
    v_exp_f32 v112, v60
    v_exp_f32 v113, v61
    v_smfmac_f32_32x32x32_bf16 v[38:53], v[172:175], v[156:163], v176
    v_exp_f32 v114, v62
    v_exp_f32 v115, v63
    v_exp_f32 v116, v64
    v_exp_f32 v117, v65
    v_exp_f32 v118, v66
    v_exp_f32 v119, v67
    v_exp_f32 v120, v68
    v_exp_f32 v121, v69
    s_setprio 3
    v_fmac_f32 v20, v20, v106
    v_fmac_f32 v21, v21, v107
    v_fmac_f32 v22, v22, v108
    v_fmac_f32 v23, v23, v109
    v_fmac_f32 v24, v24, v110
    v_fmac_f32 v25, v25, v111
    v_fmac_f32 v26, v26, v112
    v_fmac_f32 v27, v27, v113
    v_fmac_f32 v28, v28, v114
    v_fmac_f32 v29, v29, v115
    v_fmac_f32 v30, v30, v116
    v_fmac_f32 v31, v31, v117
    v_fmac_f32 v32, v32, v118
    v_fmac_f32 v33, v33, v119
    v_fmac_f32 v34, v34, v120
    v_fmac_f32 v35, v35, v121
    v_fmac_f32 v20, v54, v88
    v_fmac_f32 v21, v55, v89
    v_fmac_f32 v22, v56, v90
    v_fmac_f32 v23, v57, v91
    v_fmac_f32 v24, v58, v92
    v_fmac_f32 v25, v59, v93
    v_fmac_f32 v26, v60, v94
    v_fmac_f32 v27, v61, v95
    v_fmac_f32 v28, v62, v96
    v_fmac_f32 v29, v63, v97
    v_fmac_f32 v30, v64, v98
    v_fmac_f32 v31, v65, v99
    v_fmac_f32 v32, v66, v100
    v_fmac_f32 v33, v67, v101
    v_fmac_f32 v34, v68, v102
    v_fmac_f32 v35, v69, v103
    v_fmac_f32 v88, v88, v106
    v_fmac_f32 v89, v89, v107
    v_fmac_f32 v90, v90, v108
    v_fmac_f32 v91, v91, v109
    v_fmac_f32 v92, v92, v110
    v_fmac_f32 v93, v93, v111
    v_fmac_f32 v94, v94, v112
    v_fmac_f32 v95, v95, v113
    v_fmac_f32 v96, v96, v114
    v_fmac_f32 v97, v97, v115
    v_fmac_f32 v98, v98, v116
    v_fmac_f32 v99, v99, v117
    v_fmac_f32 v100, v100, v118
    v_fmac_f32 v101, v101, v119
    v_fmac_f32 v102, v102, v120
    v_fmac_f32 v103, v103, v121
    s_mov_b64 exec, -1
    s_waitcnt vmcnt(0) lgkmcnt(0)
    s_add_u32 m0, s86, 0
    ds_read_b128 v[156:159], v200 offset:32768
    ds_read_b128 v[160:163], v201 offset:32768
    ds_read_b64 v[186:187], v237 offset:24576
    buffer_load_dwordx4 v[188:189], s[28:31], 0 idxen offen offset:0 sc1 lds
    buffer_load_dwordx4 v[190:191], s[28:31], 0 idxen offen offset:1024 sc1 lds
    buffer_load_dwordx4 v[192:193], s[28:31], 0 idxen offen offset:2048 sc1 lds
    buffer_load_dwordx4 v[194:195], s[28:31], 0 idxen offen offset:3072 sc1 lds
    s_mov_b64 exec, s[56:57]
    s_setprio 1
    v_exp_f32 v106, v38
    v_exp_f32 v107, v39
    v_exp_f32 v108, v40
    v_mfma_f32_32x32x8_bf16 v[54:69], v[182:183], v[184:185], v[140:155]
    v_exp_f32 v109, v41
    v_exp_f32 v110, v42
    v_exp_f32 v111, v43
    v_exp_f32 v112, v44
    v_exp_f32 v113, v45
    v_smfmac_f32_32x32x32_bf16 v[54:69], v[172:175], v[164:171], v176
    v_exp_f32 v114, v46
    v_exp_f32 v115, v47
    v_exp_f32 v116, v48
    v_exp_f32 v117, v49
    v_exp_f32 v118, v50
    v_exp_f32 v119, v51
    v_exp_f32 v120, v52
    v_exp_f32 v121, v53
    s_setprio 3
    v_fmac_f32 v4, v4, v106
    v_fmac_f32 v5, v5, v107
    v_fmac_f32 v6, v6, v108
    v_fmac_f32 v7, v7, v109
    v_fmac_f32 v8, v8, v110
    v_fmac_f32 v9, v9, v111
    v_fmac_f32 v10, v10, v112
    v_fmac_f32 v11, v11, v113
    v_fmac_f32 v12, v12, v114
    v_fmac_f32 v13, v13, v115
    v_fmac_f32 v14, v14, v116
    v_fmac_f32 v15, v15, v117
    v_fmac_f32 v16, v16, v118
    v_fmac_f32 v17, v17, v119
    v_fmac_f32 v18, v18, v120
    v_fmac_f32 v19, v19, v121
    v_fmac_f32 v4, v38, v72
    v_fmac_f32 v5, v39, v73
    v_fmac_f32 v6, v40, v74
    v_fmac_f32 v7, v41, v75
    v_fmac_f32 v8, v42, v76
    v_fmac_f32 v9, v43, v77
    v_fmac_f32 v10, v44, v78
    v_fmac_f32 v11, v45, v79
    v_fmac_f32 v12, v46, v80
    v_fmac_f32 v13, v47, v81
    v_fmac_f32 v14, v48, v82
    v_fmac_f32 v15, v49, v83
    v_fmac_f32 v16, v50, v84
    v_fmac_f32 v17, v51, v85
    v_fmac_f32 v18, v52, v86
    v_fmac_f32 v19, v53, v87
    v_fmac_f32 v72, v72, v106
    v_fmac_f32 v73, v73, v107
    v_fmac_f32 v74, v74, v108
    v_fmac_f32 v75, v75, v109
    v_fmac_f32 v76, v76, v110
    v_fmac_f32 v77, v77, v111
    v_fmac_f32 v78, v78, v112
    v_fmac_f32 v79, v79, v113
    v_fmac_f32 v80, v80, v114
    v_fmac_f32 v81, v81, v115
    v_fmac_f32 v82, v82, v116
    v_fmac_f32 v83, v83, v117
    v_fmac_f32 v84, v84, v118
    v_fmac_f32 v85, v85, v119
    v_fmac_f32 v86, v86, v120
    v_fmac_f32 v87, v87, v121
    s_mov_b64 exec, -1
    s_waitcnt lgkmcnt(0)
    ds_read_b128 v[164:167], v202 offset:32768
    ds_read_b128 v[168:171], v203 offset:32768
    ds_read_u16 v188, v196 offset:28
    ds_read_u16 v190, v197 offset:28
    ds_read_u16 v192, v198 offset:28
    ds_read_u16 v194, v199 offset:28
    ds_read_u16 v237, v236 offset:26
    s_mov_b64 exec, s[56:57]
    s_setprio 1
    v_exp_f32 v106, v54
    v_exp_f32 v107, v55
    v_exp_f32 v108, v56
    v_mfma_f32_32x32x8_bf16 v[38:53], v[180:181], v[186:187], v[124:139]
    v_exp_f32 v109, v57
    v_exp_f32 v110, v58
    v_exp_f32 v111, v59
    v_exp_f32 v112, v60
    v_exp_f32 v113, v61
    v_smfmac_f32_32x32x32_bf16 v[38:53], v[172:175], v[156:163], v176
    v_exp_f32 v114, v62
    v_exp_f32 v115, v63
    v_exp_f32 v116, v64
    v_exp_f32 v117, v65
    v_exp_f32 v118, v66
    v_exp_f32 v119, v67
    v_exp_f32 v120, v68
    v_exp_f32 v121, v69
    s_setprio 3
    v_fmac_f32 v20, v20, v106
    v_fmac_f32 v21, v21, v107
    v_fmac_f32 v22, v22, v108
    v_fmac_f32 v23, v23, v109
    v_fmac_f32 v24, v24, v110
    v_fmac_f32 v25, v25, v111
    v_fmac_f32 v26, v26, v112
    v_fmac_f32 v27, v27, v113
    v_fmac_f32 v28, v28, v114
    v_fmac_f32 v29, v29, v115
    v_fmac_f32 v30, v30, v116
    v_fmac_f32 v31, v31, v117
    v_fmac_f32 v32, v32, v118
    v_fmac_f32 v33, v33, v119
    v_fmac_f32 v34, v34, v120
    v_fmac_f32 v35, v35, v121
    v_fmac_f32 v20, v54, v88
    v_fmac_f32 v21, v55, v89
    v_fmac_f32 v22, v56, v90
    v_fmac_f32 v23, v57, v91
    v_fmac_f32 v24, v58, v92
    v_fmac_f32 v25, v59, v93
    v_fmac_f32 v26, v60, v94
    v_fmac_f32 v27, v61, v95
    v_fmac_f32 v28, v62, v96
    v_fmac_f32 v29, v63, v97
    v_fmac_f32 v30, v64, v98
    v_fmac_f32 v31, v65, v99
    v_fmac_f32 v32, v66, v100
    v_fmac_f32 v33, v67, v101
    v_fmac_f32 v34, v68, v102
    v_fmac_f32 v35, v69, v103
    v_fmac_f32 v88, v88, v106
    v_fmac_f32 v89, v89, v107
    v_fmac_f32 v90, v90, v108
    v_fmac_f32 v91, v91, v109
    v_fmac_f32 v92, v92, v110
    v_fmac_f32 v93, v93, v111
    v_fmac_f32 v94, v94, v112
    v_fmac_f32 v95, v95, v113
    v_fmac_f32 v96, v96, v114
    v_fmac_f32 v97, v97, v115
    v_fmac_f32 v98, v98, v116
    v_fmac_f32 v99, v99, v117
    v_fmac_f32 v100, v100, v118
    v_fmac_f32 v101, v101, v119
    v_fmac_f32 v102, v102, v120
    v_fmac_f32 v103, v103, v121
    s_mov_b64 exec, -1
    s_waitcnt vmcnt(0) lgkmcnt(0)
    s_add_u32 m0, s86, 32768
    ds_read_b128 v[156:159], v200 offset:0
    ds_read_b128 v[160:163], v201 offset:0
    ds_read_b64 v[184:185], v237 offset:24576
    buffer_load_dwordx4 v[188:189], s[28:31], 0 idxen offen offset:0 sc1 lds
    buffer_load_dwordx4 v[190:191], s[28:31], 0 idxen offen offset:1024 sc1 lds
    buffer_load_dwordx4 v[192:193], s[28:31], 0 idxen offen offset:2048 sc1 lds
    buffer_load_dwordx4 v[194:195], s[28:31], 0 idxen offen offset:3072 sc1 lds
    s_mov_b64 exec, s[58:59]
    s_setprio 1
    v_exp_f32 v106, v38
    v_exp_f32 v107, v39
    v_exp_f32 v108, v40
    v_mfma_f32_32x32x8_bf16 v[54:69], v[182:183], v[186:187], v[140:155]
    v_exp_f32 v109, v41
    v_exp_f32 v110, v42
    v_exp_f32 v111, v43
    v_exp_f32 v112, v44
    v_exp_f32 v113, v45
    v_smfmac_f32_32x32x32_bf16 v[54:69], v[172:175], v[164:171], v176
    v_exp_f32 v114, v46
    v_exp_f32 v115, v47
    v_exp_f32 v116, v48
    v_exp_f32 v117, v49
    v_exp_f32 v118, v50
    v_exp_f32 v119, v51
    v_exp_f32 v120, v52
    v_exp_f32 v121, v53
    s_setprio 3
    v_fmac_f32 v4, v4, v106
    v_fmac_f32 v5, v5, v107
    v_fmac_f32 v6, v6, v108
    v_fmac_f32 v7, v7, v109
    v_fmac_f32 v8, v8, v110
    v_fmac_f32 v9, v9, v111
    v_fmac_f32 v10, v10, v112
    v_fmac_f32 v11, v11, v113
    v_fmac_f32 v12, v12, v114
    v_fmac_f32 v13, v13, v115
    v_fmac_f32 v14, v14, v116
    v_fmac_f32 v15, v15, v117
    v_fmac_f32 v16, v16, v118
    v_fmac_f32 v17, v17, v119
    v_fmac_f32 v18, v18, v120
    v_fmac_f32 v19, v19, v121
    v_fmac_f32 v4, v38, v72
    v_fmac_f32 v5, v39, v73
    v_fmac_f32 v6, v40, v74
    v_fmac_f32 v7, v41, v75
    v_fmac_f32 v8, v42, v76
    v_fmac_f32 v9, v43, v77
    v_fmac_f32 v10, v44, v78
    v_fmac_f32 v11, v45, v79
    v_fmac_f32 v12, v46, v80
    v_fmac_f32 v13, v47, v81
    v_fmac_f32 v14, v48, v82
    v_fmac_f32 v15, v49, v83
    v_fmac_f32 v16, v50, v84
    v_fmac_f32 v17, v51, v85
    v_fmac_f32 v18, v52, v86
    v_fmac_f32 v19, v53, v87
    v_fmac_f32 v72, v72, v106
    v_fmac_f32 v73, v73, v107
    v_fmac_f32 v74, v74, v108
    v_fmac_f32 v75, v75, v109
    v_fmac_f32 v76, v76, v110
    v_fmac_f32 v77, v77, v111
    v_fmac_f32 v78, v78, v112
    v_fmac_f32 v79, v79, v113
    v_fmac_f32 v80, v80, v114
    v_fmac_f32 v81, v81, v115
    v_fmac_f32 v82, v82, v116
    v_fmac_f32 v83, v83, v117
    v_fmac_f32 v84, v84, v118
    v_fmac_f32 v85, v85, v119
    v_fmac_f32 v86, v86, v120
    v_fmac_f32 v87, v87, v121
    s_mov_b64 exec, -1
    s_waitcnt lgkmcnt(0)
    ds_read_b128 v[164:167], v202 offset:0
    ds_read_b128 v[168:171], v203 offset:0
    ds_read_u16 v188, v196 offset:32
    ds_read_u16 v190, v197 offset:32
    ds_read_u16 v192, v198 offset:32
    ds_read_u16 v194, v199 offset:32
    ds_read_u16 v237, v236 offset:30
    s_mov_b64 exec, s[58:59]
    s_setprio 1
    v_exp_f32 v106, v54
    v_exp_f32 v107, v55
    v_exp_f32 v108, v56
    v_mfma_f32_32x32x8_bf16 v[38:53], v[180:181], v[184:185], v[124:139]
    v_exp_f32 v109, v57
    v_exp_f32 v110, v58
    v_exp_f32 v111, v59
    v_exp_f32 v112, v60
    v_exp_f32 v113, v61
    v_smfmac_f32_32x32x32_bf16 v[38:53], v[172:175], v[156:163], v176
    v_exp_f32 v114, v62
    v_exp_f32 v115, v63
    v_exp_f32 v116, v64
    v_exp_f32 v117, v65
    v_exp_f32 v118, v66
    v_exp_f32 v119, v67
    v_exp_f32 v120, v68
    v_exp_f32 v121, v69
    s_setprio 3
    v_fmac_f32 v20, v20, v106
    v_fmac_f32 v21, v21, v107
    v_fmac_f32 v22, v22, v108
    v_fmac_f32 v23, v23, v109
    v_fmac_f32 v24, v24, v110
    v_fmac_f32 v25, v25, v111
    v_fmac_f32 v26, v26, v112
    v_fmac_f32 v27, v27, v113
    v_fmac_f32 v28, v28, v114
    v_fmac_f32 v29, v29, v115
    v_fmac_f32 v30, v30, v116
    v_fmac_f32 v31, v31, v117
    v_fmac_f32 v32, v32, v118
    v_fmac_f32 v33, v33, v119
    v_fmac_f32 v34, v34, v120
    v_fmac_f32 v35, v35, v121
    v_fmac_f32 v20, v54, v88
    v_fmac_f32 v21, v55, v89
    v_fmac_f32 v22, v56, v90
    v_fmac_f32 v23, v57, v91
    v_fmac_f32 v24, v58, v92
    v_fmac_f32 v25, v59, v93
    v_fmac_f32 v26, v60, v94
    v_fmac_f32 v27, v61, v95
    v_fmac_f32 v28, v62, v96
    v_fmac_f32 v29, v63, v97
    v_fmac_f32 v30, v64, v98
    v_fmac_f32 v31, v65, v99
    v_fmac_f32 v32, v66, v100
    v_fmac_f32 v33, v67, v101
    v_fmac_f32 v34, v68, v102
    v_fmac_f32 v35, v69, v103
    v_fmac_f32 v88, v88, v106
    v_fmac_f32 v89, v89, v107
    v_fmac_f32 v90, v90, v108
    v_fmac_f32 v91, v91, v109
    v_fmac_f32 v92, v92, v110
    v_fmac_f32 v93, v93, v111
    v_fmac_f32 v94, v94, v112
    v_fmac_f32 v95, v95, v113
    v_fmac_f32 v96, v96, v114
    v_fmac_f32 v97, v97, v115
    v_fmac_f32 v98, v98, v116
    v_fmac_f32 v99, v99, v117
    v_fmac_f32 v100, v100, v118
    v_fmac_f32 v101, v101, v119
    v_fmac_f32 v102, v102, v120
    v_fmac_f32 v103, v103, v121
    s_branch K_PGB1
.p2align 12
K_STB1:
    s_setpc_b64 s[0:1]
K_PGB1:
    s_mov_b64 exec, -1
    s_waitcnt vmcnt(0) lgkmcnt(0)
    s_add_u32 m0, s86, 0
    ds_read_b128 v[156:159], v200 offset:32768
    ds_read_b128 v[160:163], v201 offset:32768
    ds_read_b64 v[186:187], v237 offset:24576
    buffer_load_dwordx4 v[188:189], s[28:31], 0 idxen offen offset:0 sc1 lds
    buffer_load_dwordx4 v[190:191], s[28:31], 0 idxen offen offset:1024 sc1 lds
    buffer_load_dwordx4 v[192:193], s[28:31], 0 idxen offen offset:2048 sc1 lds
    buffer_load_dwordx4 v[194:195], s[28:31], 0 idxen offen offset:3072 sc1 lds
    s_mov_b64 exec, s[60:61]
    s_setprio 1
    v_exp_f32 v106, v38
    v_exp_f32 v107, v39
    v_exp_f32 v108, v40
    v_mfma_f32_32x32x8_bf16 v[54:69], v[182:183], v[184:185], v[140:155]
    v_exp_f32 v109, v41
    v_exp_f32 v110, v42
    v_exp_f32 v111, v43
    v_exp_f32 v112, v44
    v_exp_f32 v113, v45
    v_smfmac_f32_32x32x32_bf16 v[54:69], v[172:175], v[164:171], v176
    v_exp_f32 v114, v46
    v_exp_f32 v115, v47
    v_exp_f32 v116, v48
    v_exp_f32 v117, v49
    v_exp_f32 v118, v50
    v_exp_f32 v119, v51
    v_exp_f32 v120, v52
    v_exp_f32 v121, v53
    s_setprio 3
    v_fmac_f32 v4, v4, v106
    v_fmac_f32 v5, v5, v107
    v_fmac_f32 v6, v6, v108
    v_fmac_f32 v7, v7, v109
    v_fmac_f32 v8, v8, v110
    v_fmac_f32 v9, v9, v111
    v_fmac_f32 v10, v10, v112
    v_fmac_f32 v11, v11, v113
    v_fmac_f32 v12, v12, v114
    v_fmac_f32 v13, v13, v115
    v_fmac_f32 v14, v14, v116
    v_fmac_f32 v15, v15, v117
    v_fmac_f32 v16, v16, v118
    v_fmac_f32 v17, v17, v119
    v_fmac_f32 v18, v18, v120
    v_fmac_f32 v19, v19, v121
    v_fmac_f32 v4, v38, v72
    v_fmac_f32 v5, v39, v73
    v_fmac_f32 v6, v40, v74
    v_fmac_f32 v7, v41, v75
    v_fmac_f32 v8, v42, v76
    v_fmac_f32 v9, v43, v77
    v_fmac_f32 v10, v44, v78
    v_fmac_f32 v11, v45, v79
    v_fmac_f32 v12, v46, v80
    v_fmac_f32 v13, v47, v81
    v_fmac_f32 v14, v48, v82
    v_fmac_f32 v15, v49, v83
    v_fmac_f32 v16, v50, v84
    v_fmac_f32 v17, v51, v85
    v_fmac_f32 v18, v52, v86
    v_fmac_f32 v19, v53, v87
    v_fmac_f32 v72, v72, v106
    v_fmac_f32 v73, v73, v107
    v_fmac_f32 v74, v74, v108
    v_fmac_f32 v75, v75, v109
    v_fmac_f32 v76, v76, v110
    v_fmac_f32 v77, v77, v111
    v_fmac_f32 v78, v78, v112
    v_fmac_f32 v79, v79, v113
    v_fmac_f32 v80, v80, v114
    v_fmac_f32 v81, v81, v115
    v_fmac_f32 v82, v82, v116
    v_fmac_f32 v83, v83, v117
    v_fmac_f32 v84, v84, v118
    v_fmac_f32 v85, v85, v119
    v_fmac_f32 v86, v86, v120
    v_fmac_f32 v87, v87, v121
    s_mov_b64 exec, -1
    s_waitcnt lgkmcnt(0)
    ds_read_b128 v[164:167], v202 offset:32768
    ds_read_b128 v[168:171], v203 offset:32768
    ds_read_u16 v188, v196 offset:36
    ds_read_u16 v190, v197 offset:36
    ds_read_u16 v192, v198 offset:36
    ds_read_u16 v194, v199 offset:36
    ds_read_u16 v237, v236 offset:34
    s_mov_b64 exec, s[60:61]
    s_setprio 1
    v_exp_f32 v106, v54
    v_exp_f32 v107, v55
    v_exp_f32 v108, v56
    v_mfma_f32_32x32x8_bf16 v[38:53], v[180:181], v[186:187], v[124:139]
    v_exp_f32 v109, v57
    v_exp_f32 v110, v58
    v_exp_f32 v111, v59
    v_exp_f32 v112, v60
    v_exp_f32 v113, v61
    v_smfmac_f32_32x32x32_bf16 v[38:53], v[172:175], v[156:163], v176
    v_exp_f32 v114, v62
    v_exp_f32 v115, v63
    v_exp_f32 v116, v64
    v_exp_f32 v117, v65
    v_exp_f32 v118, v66
    v_exp_f32 v119, v67
    v_exp_f32 v120, v68
    v_exp_f32 v121, v69
    s_setprio 3
    v_fmac_f32 v20, v20, v106
    v_fmac_f32 v21, v21, v107
    v_fmac_f32 v22, v22, v108
    v_fmac_f32 v23, v23, v109
    v_fmac_f32 v24, v24, v110
    v_fmac_f32 v25, v25, v111
    v_fmac_f32 v26, v26, v112
    v_fmac_f32 v27, v27, v113
    v_fmac_f32 v28, v28, v114
    v_fmac_f32 v29, v29, v115
    v_fmac_f32 v30, v30, v116
    v_fmac_f32 v31, v31, v117
    v_fmac_f32 v32, v32, v118
    v_fmac_f32 v33, v33, v119
    v_fmac_f32 v34, v34, v120
    v_fmac_f32 v35, v35, v121
    v_fmac_f32 v20, v54, v88
    v_fmac_f32 v21, v55, v89
    v_fmac_f32 v22, v56, v90
    v_fmac_f32 v23, v57, v91
    v_fmac_f32 v24, v58, v92
    v_fmac_f32 v25, v59, v93
    v_fmac_f32 v26, v60, v94
    v_fmac_f32 v27, v61, v95
    v_fmac_f32 v28, v62, v96
    v_fmac_f32 v29, v63, v97
    v_fmac_f32 v30, v64, v98
    v_fmac_f32 v31, v65, v99
    v_fmac_f32 v32, v66, v100
    v_fmac_f32 v33, v67, v101
    v_fmac_f32 v34, v68, v102
    v_fmac_f32 v35, v69, v103
    v_fmac_f32 v88, v88, v106
    v_fmac_f32 v89, v89, v107
    v_fmac_f32 v90, v90, v108
    v_fmac_f32 v91, v91, v109
    v_fmac_f32 v92, v92, v110
    v_fmac_f32 v93, v93, v111
    v_fmac_f32 v94, v94, v112
    v_fmac_f32 v95, v95, v113
    v_fmac_f32 v96, v96, v114
    v_fmac_f32 v97, v97, v115
    v_fmac_f32 v98, v98, v116
    v_fmac_f32 v99, v99, v117
    v_fmac_f32 v100, v100, v118
    v_fmac_f32 v101, v101, v119
    v_fmac_f32 v102, v102, v120
    v_fmac_f32 v103, v103, v121
    s_mov_b64 exec, -1
    s_waitcnt vmcnt(0) lgkmcnt(0)
    s_add_u32 m0, s86, 32768
    ds_read_b128 v[156:159], v200 offset:0
    ds_read_b128 v[160:163], v201 offset:0
    ds_read_b64 v[184:185], v237 offset:24576
    buffer_load_dwordx4 v[188:189], s[28:31], 0 idxen offen offset:0 sc1 lds
    buffer_load_dwordx4 v[190:191], s[28:31], 0 idxen offen offset:1024 sc1 lds
    buffer_load_dwordx4 v[192:193], s[28:31], 0 idxen offen offset:2048 sc1 lds
    buffer_load_dwordx4 v[194:195], s[28:31], 0 idxen offen offset:3072 sc1 lds
    s_mov_b64 exec, s[62:63]
    s_setprio 1
    v_exp_f32 v106, v38
    v_exp_f32 v107, v39
    v_exp_f32 v108, v40
    v_mfma_f32_32x32x8_bf16 v[54:69], v[182:183], v[186:187], v[140:155]
    v_exp_f32 v109, v41
    v_exp_f32 v110, v42
    v_exp_f32 v111, v43
    v_exp_f32 v112, v44
    v_exp_f32 v113, v45
    v_smfmac_f32_32x32x32_bf16 v[54:69], v[172:175], v[164:171], v176
    v_exp_f32 v114, v46
    v_exp_f32 v115, v47
    v_exp_f32 v116, v48
    v_exp_f32 v117, v49
    v_exp_f32 v118, v50
    v_exp_f32 v119, v51
    v_exp_f32 v120, v52
    v_exp_f32 v121, v53
    s_setprio 3
    v_fmac_f32 v4, v4, v106
    v_fmac_f32 v5, v5, v107
    v_fmac_f32 v6, v6, v108
    v_fmac_f32 v7, v7, v109
    v_fmac_f32 v8, v8, v110
    v_fmac_f32 v9, v9, v111
    v_fmac_f32 v10, v10, v112
    v_fmac_f32 v11, v11, v113
    v_fmac_f32 v12, v12, v114
    v_fmac_f32 v13, v13, v115
    v_fmac_f32 v14, v14, v116
    v_fmac_f32 v15, v15, v117
    v_fmac_f32 v16, v16, v118
    v_fmac_f32 v17, v17, v119
    v_fmac_f32 v18, v18, v120
    v_fmac_f32 v19, v19, v121
    v_fmac_f32 v4, v38, v72
    v_fmac_f32 v5, v39, v73
    v_fmac_f32 v6, v40, v74
    v_fmac_f32 v7, v41, v75
    v_fmac_f32 v8, v42, v76
    v_fmac_f32 v9, v43, v77
    v_fmac_f32 v10, v44, v78
    v_fmac_f32 v11, v45, v79
    v_fmac_f32 v12, v46, v80
    v_fmac_f32 v13, v47, v81
    v_fmac_f32 v14, v48, v82
    v_fmac_f32 v15, v49, v83
    v_fmac_f32 v16, v50, v84
    v_fmac_f32 v17, v51, v85
    v_fmac_f32 v18, v52, v86
    v_fmac_f32 v19, v53, v87
    v_fmac_f32 v72, v72, v106
    v_fmac_f32 v73, v73, v107
    v_fmac_f32 v74, v74, v108
    v_fmac_f32 v75, v75, v109
    v_fmac_f32 v76, v76, v110
    v_fmac_f32 v77, v77, v111
    v_fmac_f32 v78, v78, v112
    v_fmac_f32 v79, v79, v113
    v_fmac_f32 v80, v80, v114
    v_fmac_f32 v81, v81, v115
    v_fmac_f32 v82, v82, v116
    v_fmac_f32 v83, v83, v117
    v_fmac_f32 v84, v84, v118
    v_fmac_f32 v85, v85, v119
    v_fmac_f32 v86, v86, v120
    v_fmac_f32 v87, v87, v121
    s_mov_b64 exec, -1
    s_waitcnt lgkmcnt(0)
    ds_read_b128 v[164:167], v202 offset:0
    ds_read_b128 v[168:171], v203 offset:0
    ds_read_u16 v188, v196 offset:40
    ds_read_u16 v190, v197 offset:40
    ds_read_u16 v192, v198 offset:40
    ds_read_u16 v194, v199 offset:40
    ds_read_u16 v237, v236 offset:38
    s_mov_b64 exec, s[62:63]
    s_setprio 1
    v_exp_f32 v106, v54
    v_exp_f32 v107, v55
    v_exp_f32 v108, v56
    v_mfma_f32_32x32x8_bf16 v[38:53], v[180:181], v[184:185], v[124:139]
    v_exp_f32 v109, v57
    v_exp_f32 v110, v58
    v_exp_f32 v111, v59
    v_exp_f32 v112, v60
    v_exp_f32 v113, v61
    v_smfmac_f32_32x32x32_bf16 v[38:53], v[172:175], v[156:163], v176
    v_exp_f32 v114, v62
    v_exp_f32 v115, v63
    v_exp_f32 v116, v64
    v_exp_f32 v117, v65
    v_exp_f32 v118, v66
    v_exp_f32 v119, v67
    v_exp_f32 v120, v68
    v_exp_f32 v121, v69
    s_setprio 3
    v_fmac_f32 v20, v20, v106
    v_fmac_f32 v21, v21, v107
    v_fmac_f32 v22, v22, v108
    v_fmac_f32 v23, v23, v109
    v_fmac_f32 v24, v24, v110
    v_fmac_f32 v25, v25, v111
    v_fmac_f32 v26, v26, v112
    v_fmac_f32 v27, v27, v113
    v_fmac_f32 v28, v28, v114
    v_fmac_f32 v29, v29, v115
    v_fmac_f32 v30, v30, v116
    v_fmac_f32 v31, v31, v117
    v_fmac_f32 v32, v32, v118
    v_fmac_f32 v33, v33, v119
    v_fmac_f32 v34, v34, v120
    v_fmac_f32 v35, v35, v121
    v_fmac_f32 v20, v54, v88
    v_fmac_f32 v21, v55, v89
    v_fmac_f32 v22, v56, v90
    v_fmac_f32 v23, v57, v91
    v_fmac_f32 v24, v58, v92
    v_fmac_f32 v25, v59, v93
    v_fmac_f32 v26, v60, v94
    v_fmac_f32 v27, v61, v95
    v_fmac_f32 v28, v62, v96
    v_fmac_f32 v29, v63, v97
    v_fmac_f32 v30, v64, v98
    v_fmac_f32 v31, v65, v99
    v_fmac_f32 v32, v66, v100
    v_fmac_f32 v33, v67, v101
    v_fmac_f32 v34, v68, v102
    v_fmac_f32 v35, v69, v103
    v_fmac_f32 v88, v88, v106
    v_fmac_f32 v89, v89, v107
    v_fmac_f32 v90, v90, v108
    v_fmac_f32 v91, v91, v109
    v_fmac_f32 v92, v92, v110
    v_fmac_f32 v93, v93, v111
    v_fmac_f32 v94, v94, v112
    v_fmac_f32 v95, v95, v113
    v_fmac_f32 v96, v96, v114
    v_fmac_f32 v97, v97, v115
    v_fmac_f32 v98, v98, v116
    v_fmac_f32 v99, v99, v117
    v_fmac_f32 v100, v100, v118
    v_fmac_f32 v101, v101, v119
    v_fmac_f32 v102, v102, v120
    v_fmac_f32 v103, v103, v121
    s_mov_b64 exec, -1
    s_waitcnt vmcnt(0) lgkmcnt(0)
    s_add_u32 m0, s86, 0
    ds_read_b128 v[156:159], v200 offset:32768
    ds_read_b128 v[160:163], v201 offset:32768
    ds_read_b64 v[186:187], v237 offset:24576
    buffer_load_dwordx4 v[188:189], s[28:31], 0 idxen offen offset:0 sc1 lds
    buffer_load_dwordx4 v[190:191], s[28:31], 0 idxen offen offset:1024 sc1 lds
    buffer_load_dwordx4 v[192:193], s[28:31], 0 idxen offen offset:2048 sc1 lds
    buffer_load_dwordx4 v[194:195], s[28:31], 0 idxen offen offset:3072 sc1 lds
    s_mov_b64 exec, s[64:65]
    s_setprio 1
    v_exp_f32 v106, v38
    v_exp_f32 v107, v39
    v_exp_f32 v108, v40
    v_mfma_f32_32x32x8_bf16 v[54:69], v[182:183], v[184:185], v[140:155]
    v_exp_f32 v109, v41
    v_exp_f32 v110, v42
    v_exp_f32 v111, v43
    v_exp_f32 v112, v44
    v_exp_f32 v113, v45
    v_smfmac_f32_32x32x32_bf16 v[54:69], v[172:175], v[164:171], v176
    v_exp_f32 v114, v46
    v_exp_f32 v115, v47
    v_exp_f32 v116, v48
    v_exp_f32 v117, v49
    v_exp_f32 v118, v50
    v_exp_f32 v119, v51
    v_exp_f32 v120, v52
    v_exp_f32 v121, v53
    s_setprio 3
    v_fmac_f32 v4, v4, v106
    v_fmac_f32 v5, v5, v107
    v_fmac_f32 v6, v6, v108
    v_fmac_f32 v7, v7, v109
    v_fmac_f32 v8, v8, v110
    v_fmac_f32 v9, v9, v111
    v_fmac_f32 v10, v10, v112
    v_fmac_f32 v11, v11, v113
    v_fmac_f32 v12, v12, v114
    v_fmac_f32 v13, v13, v115
    v_fmac_f32 v14, v14, v116
    v_fmac_f32 v15, v15, v117
    v_fmac_f32 v16, v16, v118
    v_fmac_f32 v17, v17, v119
    v_fmac_f32 v18, v18, v120
    v_fmac_f32 v19, v19, v121
    v_fmac_f32 v4, v38, v72
    v_fmac_f32 v5, v39, v73
    v_fmac_f32 v6, v40, v74
    v_fmac_f32 v7, v41, v75
    v_fmac_f32 v8, v42, v76
    v_fmac_f32 v9, v43, v77
    v_fmac_f32 v10, v44, v78
    v_fmac_f32 v11, v45, v79
    v_fmac_f32 v12, v46, v80
    v_fmac_f32 v13, v47, v81
    v_fmac_f32 v14, v48, v82
    v_fmac_f32 v15, v49, v83
    v_fmac_f32 v16, v50, v84
    v_fmac_f32 v17, v51, v85
    v_fmac_f32 v18, v52, v86
    v_fmac_f32 v19, v53, v87
    v_fmac_f32 v72, v72, v106
    v_fmac_f32 v73, v73, v107
    v_fmac_f32 v74, v74, v108
    v_fmac_f32 v75, v75, v109
    v_fmac_f32 v76, v76, v110
    v_fmac_f32 v77, v77, v111
    v_fmac_f32 v78, v78, v112
    v_fmac_f32 v79, v79, v113
    v_fmac_f32 v80, v80, v114
    v_fmac_f32 v81, v81, v115
    v_fmac_f32 v82, v82, v116
    v_fmac_f32 v83, v83, v117
    v_fmac_f32 v84, v84, v118
    v_fmac_f32 v85, v85, v119
    v_fmac_f32 v86, v86, v120
    v_fmac_f32 v87, v87, v121
    s_mov_b64 exec, -1
    s_waitcnt lgkmcnt(0)
    ds_read_b128 v[164:167], v202 offset:32768
    ds_read_b128 v[168:171], v203 offset:32768
    ds_read_u16 v188, v196 offset:44
    ds_read_u16 v190, v197 offset:44
    ds_read_u16 v192, v198 offset:44
    ds_read_u16 v194, v199 offset:44
    ds_read_u16 v237, v236 offset:42
    s_mov_b64 exec, s[64:65]
    s_setprio 1
    v_exp_f32 v106, v54
    v_exp_f32 v107, v55
    v_exp_f32 v108, v56
    v_mfma_f32_32x32x8_bf16 v[38:53], v[180:181], v[186:187], v[124:139]
    v_exp_f32 v109, v57
    v_exp_f32 v110, v58
    v_exp_f32 v111, v59
    v_exp_f32 v112, v60
    v_exp_f32 v113, v61
    v_smfmac_f32_32x32x32_bf16 v[38:53], v[172:175], v[156:163], v176
    v_exp_f32 v114, v62
    v_exp_f32 v115, v63
    v_exp_f32 v116, v64
    v_exp_f32 v117, v65
    v_exp_f32 v118, v66
    v_exp_f32 v119, v67
    v_exp_f32 v120, v68
    v_exp_f32 v121, v69
    s_setprio 3
    v_fmac_f32 v20, v20, v106
    v_fmac_f32 v21, v21, v107
    v_fmac_f32 v22, v22, v108
    v_fmac_f32 v23, v23, v109
    v_fmac_f32 v24, v24, v110
    v_fmac_f32 v25, v25, v111
    v_fmac_f32 v26, v26, v112
    v_fmac_f32 v27, v27, v113
    v_fmac_f32 v28, v28, v114
    v_fmac_f32 v29, v29, v115
    v_fmac_f32 v30, v30, v116
    v_fmac_f32 v31, v31, v117
    v_fmac_f32 v32, v32, v118
    v_fmac_f32 v33, v33, v119
    v_fmac_f32 v34, v34, v120
    v_fmac_f32 v35, v35, v121
    v_fmac_f32 v20, v54, v88
    v_fmac_f32 v21, v55, v89
    v_fmac_f32 v22, v56, v90
    v_fmac_f32 v23, v57, v91
    v_fmac_f32 v24, v58, v92
    v_fmac_f32 v25, v59, v93
    v_fmac_f32 v26, v60, v94
    v_fmac_f32 v27, v61, v95
    v_fmac_f32 v28, v62, v96
    v_fmac_f32 v29, v63, v97
    v_fmac_f32 v30, v64, v98
    v_fmac_f32 v31, v65, v99
    v_fmac_f32 v32, v66, v100
    v_fmac_f32 v33, v67, v101
    v_fmac_f32 v34, v68, v102
    v_fmac_f32 v35, v69, v103
    v_fmac_f32 v88, v88, v106
    v_fmac_f32 v89, v89, v107
    v_fmac_f32 v90, v90, v108
    v_fmac_f32 v91, v91, v109
    v_fmac_f32 v92, v92, v110
    v_fmac_f32 v93, v93, v111
    v_fmac_f32 v94, v94, v112
    v_fmac_f32 v95, v95, v113
    v_fmac_f32 v96, v96, v114
    v_fmac_f32 v97, v97, v115
    v_fmac_f32 v98, v98, v116
    v_fmac_f32 v99, v99, v117
    v_fmac_f32 v100, v100, v118
    v_fmac_f32 v101, v101, v119
    v_fmac_f32 v102, v102, v120
    v_fmac_f32 v103, v103, v121
    s_mov_b64 exec, -1
    s_waitcnt vmcnt(0) lgkmcnt(0)
    s_add_u32 m0, s86, 32768
    ds_read_b128 v[156:159], v200 offset:0
    ds_read_b128 v[160:163], v201 offset:0
    ds_read_b64 v[184:185], v237 offset:24576
    buffer_load_dwordx4 v[188:189], s[28:31], 0 idxen offen offset:0 sc1 lds
    buffer_load_dwordx4 v[190:191], s[28:31], 0 idxen offen offset:1024 sc1 lds
    buffer_load_dwordx4 v[192:193], s[28:31], 0 idxen offen offset:2048 sc1 lds
    buffer_load_dwordx4 v[194:195], s[28:31], 0 idxen offen offset:3072 sc1 lds
    s_mov_b64 exec, s[66:67]
    s_setprio 1
    v_exp_f32 v106, v38
    v_exp_f32 v107, v39
    v_exp_f32 v108, v40
    v_mfma_f32_32x32x8_bf16 v[54:69], v[182:183], v[186:187], v[140:155]
    v_exp_f32 v109, v41
    v_exp_f32 v110, v42
    v_exp_f32 v111, v43
    v_exp_f32 v112, v44
    v_exp_f32 v113, v45
    v_smfmac_f32_32x32x32_bf16 v[54:69], v[172:175], v[164:171], v176
    v_exp_f32 v114, v46
    v_exp_f32 v115, v47
    v_exp_f32 v116, v48
    v_exp_f32 v117, v49
    v_exp_f32 v118, v50
    v_exp_f32 v119, v51
    v_exp_f32 v120, v52
    v_exp_f32 v121, v53
    s_setprio 3
    v_fmac_f32 v4, v4, v106
    v_fmac_f32 v5, v5, v107
    v_fmac_f32 v6, v6, v108
    v_fmac_f32 v7, v7, v109
    v_fmac_f32 v8, v8, v110
    v_fmac_f32 v9, v9, v111
    v_fmac_f32 v10, v10, v112
    v_fmac_f32 v11, v11, v113
    v_fmac_f32 v12, v12, v114
    v_fmac_f32 v13, v13, v115
    v_fmac_f32 v14, v14, v116
    v_fmac_f32 v15, v15, v117
    v_fmac_f32 v16, v16, v118
    v_fmac_f32 v17, v17, v119
    v_fmac_f32 v18, v18, v120
    v_fmac_f32 v19, v19, v121
    v_fmac_f32 v4, v38, v72
    v_fmac_f32 v5, v39, v73
    v_fmac_f32 v6, v40, v74
    v_fmac_f32 v7, v41, v75
    v_fmac_f32 v8, v42, v76
    v_fmac_f32 v9, v43, v77
    v_fmac_f32 v10, v44, v78
    v_fmac_f32 v11, v45, v79
    v_fmac_f32 v12, v46, v80
    v_fmac_f32 v13, v47, v81
    v_fmac_f32 v14, v48, v82
    v_fmac_f32 v15, v49, v83
    v_fmac_f32 v16, v50, v84
    v_fmac_f32 v17, v51, v85
    v_fmac_f32 v18, v52, v86
    v_fmac_f32 v19, v53, v87
    v_fmac_f32 v72, v72, v106
    v_fmac_f32 v73, v73, v107
    v_fmac_f32 v74, v74, v108
    v_fmac_f32 v75, v75, v109
    v_fmac_f32 v76, v76, v110
    v_fmac_f32 v77, v77, v111
    v_fmac_f32 v78, v78, v112
    v_fmac_f32 v79, v79, v113
    v_fmac_f32 v80, v80, v114
    v_fmac_f32 v81, v81, v115
    v_fmac_f32 v82, v82, v116
    v_fmac_f32 v83, v83, v117
    v_fmac_f32 v84, v84, v118
    v_fmac_f32 v85, v85, v119
    v_fmac_f32 v86, v86, v120
    v_fmac_f32 v87, v87, v121
    s_mov_b64 exec, -1
    s_waitcnt lgkmcnt(0)
    ds_read_b128 v[164:167], v202 offset:0
    ds_read_b128 v[168:171], v203 offset:0
    ds_read_u16 v188, v196 offset:48
    ds_read_u16 v190, v197 offset:48
    ds_read_u16 v192, v198 offset:48
    ds_read_u16 v194, v199 offset:48
    ds_read_u16 v237, v236 offset:46
    s_mov_b64 exec, s[66:67]
    s_setprio 1
    v_exp_f32 v106, v54
    v_exp_f32 v107, v55
    v_exp_f32 v108, v56
    v_mfma_f32_32x32x8_bf16 v[38:53], v[180:181], v[184:185], v[124:139]
    v_exp_f32 v109, v57
    v_exp_f32 v110, v58
    v_exp_f32 v111, v59
    v_exp_f32 v112, v60
    v_exp_f32 v113, v61
    v_smfmac_f32_32x32x32_bf16 v[38:53], v[172:175], v[156:163], v176
    v_exp_f32 v114, v62
    v_exp_f32 v115, v63
    v_exp_f32 v116, v64
    v_exp_f32 v117, v65
    v_exp_f32 v118, v66
    v_exp_f32 v119, v67
    v_exp_f32 v120, v68
    v_exp_f32 v121, v69
    s_setprio 3
    v_fmac_f32 v20, v20, v106
    v_fmac_f32 v21, v21, v107
    v_fmac_f32 v22, v22, v108
    v_fmac_f32 v23, v23, v109
    v_fmac_f32 v24, v24, v110
    v_fmac_f32 v25, v25, v111
    v_fmac_f32 v26, v26, v112
    v_fmac_f32 v27, v27, v113
    v_fmac_f32 v28, v28, v114
    v_fmac_f32 v29, v29, v115
    v_fmac_f32 v30, v30, v116
    v_fmac_f32 v31, v31, v117
    v_fmac_f32 v32, v32, v118
    v_fmac_f32 v33, v33, v119
    v_fmac_f32 v34, v34, v120
    v_fmac_f32 v35, v35, v121
    v_fmac_f32 v20, v54, v88
    v_fmac_f32 v21, v55, v89
    v_fmac_f32 v22, v56, v90
    v_fmac_f32 v23, v57, v91
    v_fmac_f32 v24, v58, v92
    v_fmac_f32 v25, v59, v93
    v_fmac_f32 v26, v60, v94
    v_fmac_f32 v27, v61, v95
    v_fmac_f32 v28, v62, v96
    v_fmac_f32 v29, v63, v97
    v_fmac_f32 v30, v64, v98
    v_fmac_f32 v31, v65, v99
    v_fmac_f32 v32, v66, v100
    v_fmac_f32 v33, v67, v101
    v_fmac_f32 v34, v68, v102
    v_fmac_f32 v35, v69, v103
    v_fmac_f32 v88, v88, v106
    v_fmac_f32 v89, v89, v107
    v_fmac_f32 v90, v90, v108
    v_fmac_f32 v91, v91, v109
    v_fmac_f32 v92, v92, v110
    v_fmac_f32 v93, v93, v111
    v_fmac_f32 v94, v94, v112
    v_fmac_f32 v95, v95, v113
    v_fmac_f32 v96, v96, v114
    v_fmac_f32 v97, v97, v115
    v_fmac_f32 v98, v98, v116
    v_fmac_f32 v99, v99, v117
    v_fmac_f32 v100, v100, v118
    v_fmac_f32 v101, v101, v119
    v_fmac_f32 v102, v102, v120
    v_fmac_f32 v103, v103, v121
    s_mov_b64 exec, -1
    s_waitcnt vmcnt(0) lgkmcnt(0)
    s_add_u32 m0, s86, 0
    ds_read_b128 v[156:159], v200 offset:32768
    ds_read_b128 v[160:163], v201 offset:32768
    ds_read_b64 v[186:187], v237 offset:24576
    buffer_load_dwordx4 v[188:189], s[28:31], 0 idxen offen offset:0 sc1 lds
    buffer_load_dwordx4 v[190:191], s[28:31], 0 idxen offen offset:1024 sc1 lds
    buffer_load_dwordx4 v[192:193], s[28:31], 0 idxen offen offset:2048 sc1 lds
    buffer_load_dwordx4 v[194:195], s[28:31], 0 idxen offen offset:3072 sc1 lds
    s_mov_b64 exec, s[68:69]
    s_setprio 1
    v_exp_f32 v106, v38
    v_exp_f32 v107, v39
    v_exp_f32 v108, v40
    v_mfma_f32_32x32x8_bf16 v[54:69], v[182:183], v[184:185], v[140:155]
    v_exp_f32 v109, v41
    v_exp_f32 v110, v42
    v_exp_f32 v111, v43
    v_exp_f32 v112, v44
    v_exp_f32 v113, v45
    v_smfmac_f32_32x32x32_bf16 v[54:69], v[172:175], v[164:171], v176
    v_exp_f32 v114, v46
    v_exp_f32 v115, v47
    v_exp_f32 v116, v48
    v_exp_f32 v117, v49
    v_exp_f32 v118, v50
    v_exp_f32 v119, v51
    v_exp_f32 v120, v52
    v_exp_f32 v121, v53
    s_setprio 3
    v_fmac_f32 v4, v4, v106
    v_fmac_f32 v5, v5, v107
    v_fmac_f32 v6, v6, v108
    v_fmac_f32 v7, v7, v109
    v_fmac_f32 v8, v8, v110
    v_fmac_f32 v9, v9, v111
    v_fmac_f32 v10, v10, v112
    v_fmac_f32 v11, v11, v113
    v_fmac_f32 v12, v12, v114
    v_fmac_f32 v13, v13, v115
    v_fmac_f32 v14, v14, v116
    v_fmac_f32 v15, v15, v117
    v_fmac_f32 v16, v16, v118
    v_fmac_f32 v17, v17, v119
    v_fmac_f32 v18, v18, v120
    v_fmac_f32 v19, v19, v121
    v_fmac_f32 v4, v38, v72
    v_fmac_f32 v5, v39, v73
    v_fmac_f32 v6, v40, v74
    v_fmac_f32 v7, v41, v75
    v_fmac_f32 v8, v42, v76
    v_fmac_f32 v9, v43, v77
    v_fmac_f32 v10, v44, v78
    v_fmac_f32 v11, v45, v79
    v_fmac_f32 v12, v46, v80
    v_fmac_f32 v13, v47, v81
    v_fmac_f32 v14, v48, v82
    v_fmac_f32 v15, v49, v83
    v_fmac_f32 v16, v50, v84
    v_fmac_f32 v17, v51, v85
    v_fmac_f32 v18, v52, v86
    v_fmac_f32 v19, v53, v87
    v_fmac_f32 v72, v72, v106
    v_fmac_f32 v73, v73, v107
    v_fmac_f32 v74, v74, v108
    v_fmac_f32 v75, v75, v109
    v_fmac_f32 v76, v76, v110
    v_fmac_f32 v77, v77, v111
    v_fmac_f32 v78, v78, v112
    v_fmac_f32 v79, v79, v113
    v_fmac_f32 v80, v80, v114
    v_fmac_f32 v81, v81, v115
    v_fmac_f32 v82, v82, v116
    v_fmac_f32 v83, v83, v117
    v_fmac_f32 v84, v84, v118
    v_fmac_f32 v85, v85, v119
    v_fmac_f32 v86, v86, v120
    v_fmac_f32 v87, v87, v121
    s_mov_b64 exec, -1
    s_waitcnt lgkmcnt(0)
    ds_read_b128 v[164:167], v202 offset:32768
    ds_read_b128 v[168:171], v203 offset:32768
    ds_read_u16 v188, v196 offset:52
    ds_read_u16 v190, v197 offset:52
    ds_read_u16 v192, v198 offset:52
    ds_read_u16 v194, v199 offset:52
    ds_read_u16 v237, v236 offset:50
    s_mov_b64 exec, s[68:69]
    s_setprio 1
    v_exp_f32 v106, v54
    v_exp_f32 v107, v55
    v_exp_f32 v108, v56
    v_mfma_f32_32x32x8_bf16 v[38:53], v[180:181], v[186:187], v[124:139]
    v_exp_f32 v109, v57
    v_exp_f32 v110, v58
    v_exp_f32 v111, v59
    v_exp_f32 v112, v60
    v_exp_f32 v113, v61
    v_smfmac_f32_32x32x32_bf16 v[38:53], v[172:175], v[156:163], v176
    v_exp_f32 v114, v62
    v_exp_f32 v115, v63
    v_exp_f32 v116, v64
    v_exp_f32 v117, v65
    v_exp_f32 v118, v66
    v_exp_f32 v119, v67
    v_exp_f32 v120, v68
    v_exp_f32 v121, v69
    s_setprio 3
    v_fmac_f32 v20, v20, v106
    v_fmac_f32 v21, v21, v107
    v_fmac_f32 v22, v22, v108
    v_fmac_f32 v23, v23, v109
    v_fmac_f32 v24, v24, v110
    v_fmac_f32 v25, v25, v111
    v_fmac_f32 v26, v26, v112
    v_fmac_f32 v27, v27, v113
    v_fmac_f32 v28, v28, v114
    v_fmac_f32 v29, v29, v115
    v_fmac_f32 v30, v30, v116
    v_fmac_f32 v31, v31, v117
    v_fmac_f32 v32, v32, v118
    v_fmac_f32 v33, v33, v119
    v_fmac_f32 v34, v34, v120
    v_fmac_f32 v35, v35, v121
    v_fmac_f32 v20, v54, v88
    v_fmac_f32 v21, v55, v89
    v_fmac_f32 v22, v56, v90
    v_fmac_f32 v23, v57, v91
    v_fmac_f32 v24, v58, v92
    v_fmac_f32 v25, v59, v93
    v_fmac_f32 v26, v60, v94
    v_fmac_f32 v27, v61, v95
    v_fmac_f32 v28, v62, v96
    v_fmac_f32 v29, v63, v97
    v_fmac_f32 v30, v64, v98
    v_fmac_f32 v31, v65, v99
    v_fmac_f32 v32, v66, v100
    v_fmac_f32 v33, v67, v101
    v_fmac_f32 v34, v68, v102
    v_fmac_f32 v35, v69, v103
    v_fmac_f32 v88, v88, v106
    v_fmac_f32 v89, v89, v107
    v_fmac_f32 v90, v90, v108
    v_fmac_f32 v91, v91, v109
    v_fmac_f32 v92, v92, v110
    v_fmac_f32 v93, v93, v111
    v_fmac_f32 v94, v94, v112
    v_fmac_f32 v95, v95, v113
    v_fmac_f32 v96, v96, v114
    v_fmac_f32 v97, v97, v115
    v_fmac_f32 v98, v98, v116
    v_fmac_f32 v99, v99, v117
    v_fmac_f32 v100, v100, v118
    v_fmac_f32 v101, v101, v119
    v_fmac_f32 v102, v102, v120
    v_fmac_f32 v103, v103, v121
    s_mov_b64 exec, -1
    s_waitcnt vmcnt(0) lgkmcnt(0)
    s_add_u32 m0, s86, 32768
    ds_read_b128 v[156:159], v200 offset:0
    ds_read_b128 v[160:163], v201 offset:0
    ds_read_b64 v[184:185], v237 offset:24576
    buffer_load_dwordx4 v[188:189], s[28:31], 0 idxen offen offset:0 sc1 lds
    buffer_load_dwordx4 v[190:191], s[28:31], 0 idxen offen offset:1024 sc1 lds
    buffer_load_dwordx4 v[192:193], s[28:31], 0 idxen offen offset:2048 sc1 lds
    buffer_load_dwordx4 v[194:195], s[28:31], 0 idxen offen offset:3072 sc1 lds
    s_mov_b64 exec, s[70:71]
    s_setprio 1
    v_exp_f32 v106, v38
    v_exp_f32 v107, v39
    v_exp_f32 v108, v40
    v_mfma_f32_32x32x8_bf16 v[54:69], v[182:183], v[186:187], v[140:155]
    v_exp_f32 v109, v41
    v_exp_f32 v110, v42
    v_exp_f32 v111, v43
    v_exp_f32 v112, v44
    v_exp_f32 v113, v45
    v_smfmac_f32_32x32x32_bf16 v[54:69], v[172:175], v[164:171], v176
    v_exp_f32 v114, v46
    v_exp_f32 v115, v47
    v_exp_f32 v116, v48
    v_exp_f32 v117, v49
    v_exp_f32 v118, v50
    v_exp_f32 v119, v51
    v_exp_f32 v120, v52
    v_exp_f32 v121, v53
    s_setprio 3
    v_fmac_f32 v4, v4, v106
    v_fmac_f32 v5, v5, v107
    v_fmac_f32 v6, v6, v108
    v_fmac_f32 v7, v7, v109
    v_fmac_f32 v8, v8, v110
    v_fmac_f32 v9, v9, v111
    v_fmac_f32 v10, v10, v112
    v_fmac_f32 v11, v11, v113
    v_fmac_f32 v12, v12, v114
    v_fmac_f32 v13, v13, v115
    v_fmac_f32 v14, v14, v116
    v_fmac_f32 v15, v15, v117
    v_fmac_f32 v16, v16, v118
    v_fmac_f32 v17, v17, v119
    v_fmac_f32 v18, v18, v120
    v_fmac_f32 v19, v19, v121
    v_fmac_f32 v4, v38, v72
    v_fmac_f32 v5, v39, v73
    v_fmac_f32 v6, v40, v74
    v_fmac_f32 v7, v41, v75
    v_fmac_f32 v8, v42, v76
    v_fmac_f32 v9, v43, v77
    v_fmac_f32 v10, v44, v78
    v_fmac_f32 v11, v45, v79
    v_fmac_f32 v12, v46, v80
    v_fmac_f32 v13, v47, v81
    v_fmac_f32 v14, v48, v82
    v_fmac_f32 v15, v49, v83
    v_fmac_f32 v16, v50, v84
    v_fmac_f32 v17, v51, v85
    v_fmac_f32 v18, v52, v86
    v_fmac_f32 v19, v53, v87
    v_fmac_f32 v72, v72, v106
    v_fmac_f32 v73, v73, v107
    v_fmac_f32 v74, v74, v108
    v_fmac_f32 v75, v75, v109
    v_fmac_f32 v76, v76, v110
    v_fmac_f32 v77, v77, v111
    v_fmac_f32 v78, v78, v112
    v_fmac_f32 v79, v79, v113
    v_fmac_f32 v80, v80, v114
    v_fmac_f32 v81, v81, v115
    v_fmac_f32 v82, v82, v116
    v_fmac_f32 v83, v83, v117
    v_fmac_f32 v84, v84, v118
    v_fmac_f32 v85, v85, v119
    v_fmac_f32 v86, v86, v120
    v_fmac_f32 v87, v87, v121
    s_branch K_PGB2
.p2align 12
K_STB2:
    s_setpc_b64 s[0:1]
K_PGB2:
    s_mov_b64 exec, -1
    s_waitcnt lgkmcnt(0)
    ds_read_b128 v[164:167], v202 offset:0
    ds_read_b128 v[168:171], v203 offset:0
    ds_read_u16 v188, v196 offset:56
    ds_read_u16 v190, v197 offset:56
    ds_read_u16 v192, v198 offset:56
    ds_read_u16 v194, v199 offset:56
    ds_read_u16 v237, v236 offset:54
    s_mov_b64 exec, s[70:71]
    s_setprio 1
    v_exp_f32 v106, v54
    v_exp_f32 v107, v55
    v_exp_f32 v108, v56
    v_mfma_f32_32x32x8_bf16 v[38:53], v[180:181], v[184:185], v[124:139]
    v_exp_f32 v109, v57
    v_exp_f32 v110, v58
    v_exp_f32 v111, v59
    v_exp_f32 v112, v60
    v_exp_f32 v113, v61
    v_smfmac_f32_32x32x32_bf16 v[38:53], v[172:175], v[156:163], v176
    v_exp_f32 v114, v62
    v_exp_f32 v115, v63
    v_exp_f32 v116, v64
    v_exp_f32 v117, v65
    v_exp_f32 v118, v66
    v_exp_f32 v119, v67
    v_exp_f32 v120, v68
    v_exp_f32 v121, v69
    s_setprio 3
    v_fmac_f32 v20, v20, v106
    v_fmac_f32 v21, v21, v107
    v_fmac_f32 v22, v22, v108
    v_fmac_f32 v23, v23, v109
    v_fmac_f32 v24, v24, v110
    v_fmac_f32 v25, v25, v111
    v_fmac_f32 v26, v26, v112
    v_fmac_f32 v27, v27, v113
    v_fmac_f32 v28, v28, v114
    v_fmac_f32 v29, v29, v115
    v_fmac_f32 v30, v30, v116
    v_fmac_f32 v31, v31, v117
    v_fmac_f32 v32, v32, v118
    v_fmac_f32 v33, v33, v119
    v_fmac_f32 v34, v34, v120
    v_fmac_f32 v35, v35, v121
    v_fmac_f32 v20, v54, v88
    v_fmac_f32 v21, v55, v89
    v_fmac_f32 v22, v56, v90
    v_fmac_f32 v23, v57, v91
    v_fmac_f32 v24, v58, v92
    v_fmac_f32 v25, v59, v93
    v_fmac_f32 v26, v60, v94
    v_fmac_f32 v27, v61, v95
    v_fmac_f32 v28, v62, v96
    v_fmac_f32 v29, v63, v97
    v_fmac_f32 v30, v64, v98
    v_fmac_f32 v31, v65, v99
    v_fmac_f32 v32, v66, v100
    v_fmac_f32 v33, v67, v101
    v_fmac_f32 v34, v68, v102
    v_fmac_f32 v35, v69, v103
    v_fmac_f32 v88, v88, v106
    v_fmac_f32 v89, v89, v107
    v_fmac_f32 v90, v90, v108
    v_fmac_f32 v91, v91, v109
    v_fmac_f32 v92, v92, v110
    v_fmac_f32 v93, v93, v111
    v_fmac_f32 v94, v94, v112
    v_fmac_f32 v95, v95, v113
    v_fmac_f32 v96, v96, v114
    v_fmac_f32 v97, v97, v115
    v_fmac_f32 v98, v98, v116
    v_fmac_f32 v99, v99, v117
    v_fmac_f32 v100, v100, v118
    v_fmac_f32 v101, v101, v119
    v_fmac_f32 v102, v102, v120
    v_fmac_f32 v103, v103, v121
    s_cmp_lg_u64 s[76:77], 0
    s_cbranch_scc1 K_L15B
    s_mov_b64 exec, -1
    s_waitcnt vmcnt(0) lgkmcnt(0)
    ds_read_b128 v[156:159], v200 offset:32768
    ds_read_b128 v[160:163], v201 offset:32768
    ds_read_b64 v[186:187], v237 offset:24576
    s_mov_b64 exec, s[72:73]
    s_setprio 1
    v_exp_f32 v106, v38
    v_exp_f32 v107, v39
    v_exp_f32 v108, v40
    v_mfma_f32_32x32x8_bf16 v[54:69], v[182:183], v[184:185], v[140:155]
    v_exp_f32 v109, v41
    v_exp_f32 v110, v42
    v_exp_f32 v111, v43
    v_exp_f32 v112, v44
    v_exp_f32 v113, v45
    v_smfmac_f32_32x32x32_bf16 v[54:69], v[172:175], v[164:171], v176
    v_exp_f32 v114, v46
    v_exp_f32 v115, v47
    v_exp_f32 v116, v48
    v_exp_f32 v117, v49
    v_exp_f32 v118, v50
    v_exp_f32 v119, v51
    v_exp_f32 v120, v52
    v_exp_f32 v121, v53
    s_setprio 3
    v_fmac_f32 v4, v4, v106
    v_fmac_f32 v5, v5, v107
    v_fmac_f32 v6, v6, v108
    v_fmac_f32 v7, v7, v109
    v_fmac_f32 v8, v8, v110
    v_fmac_f32 v9, v9, v111
    v_fmac_f32 v10, v10, v112
    v_fmac_f32 v11, v11, v113
    v_fmac_f32 v12, v12, v114
    v_fmac_f32 v13, v13, v115
    v_fmac_f32 v14, v14, v116
    v_fmac_f32 v15, v15, v117
    v_fmac_f32 v16, v16, v118
    v_fmac_f32 v17, v17, v119
    v_fmac_f32 v18, v18, v120
    v_fmac_f32 v19, v19, v121
    v_fmac_f32 v4, v38, v72
    v_fmac_f32 v5, v39, v73
    v_fmac_f32 v6, v40, v74
    v_fmac_f32 v7, v41, v75
    v_fmac_f32 v8, v42, v76
    v_fmac_f32 v9, v43, v77
    v_fmac_f32 v10, v44, v78
    v_fmac_f32 v11, v45, v79
    v_fmac_f32 v12, v46, v80
    v_fmac_f32 v13, v47, v81
    v_fmac_f32 v14, v48, v82
    v_fmac_f32 v15, v49, v83
    v_fmac_f32 v16, v50, v84
    v_fmac_f32 v17, v51, v85
    v_fmac_f32 v18, v52, v86
    v_fmac_f32 v19, v53, v87
    v_fmac_f32 v72, v72, v106
    v_fmac_f32 v73, v73, v107
    v_fmac_f32 v74, v74, v108
    v_fmac_f32 v75, v75, v109
    v_fmac_f32 v76, v76, v110
    v_fmac_f32 v77, v77, v111
    v_fmac_f32 v78, v78, v112
    v_fmac_f32 v79, v79, v113
    v_fmac_f32 v80, v80, v114
    v_fmac_f32 v81, v81, v115
    v_fmac_f32 v82, v82, v116
    v_fmac_f32 v83, v83, v117
    v_fmac_f32 v84, v84, v118
    v_fmac_f32 v85, v85, v119
    v_fmac_f32 v86, v86, v120
    v_fmac_f32 v87, v87, v121
    s_mov_b64 exec, -1
    s_waitcnt lgkmcnt(0)
    ds_read_b128 v[164:167], v202 offset:32768
    ds_read_b128 v[168:171], v203 offset:32768
    s_mov_b64 exec, s[72:73]
    s_setprio 1
    v_exp_f32 v106, v54
    v_exp_f32 v107, v55
    v_exp_f32 v108, v56
    v_mfma_f32_32x32x8_bf16 v[38:53], v[180:181], v[186:187], v[124:139]
    v_exp_f32 v109, v57
    v_exp_f32 v110, v58
    v_exp_f32 v111, v59
    v_exp_f32 v112, v60
    v_exp_f32 v113, v61
    v_smfmac_f32_32x32x32_bf16 v[38:53], v[172:175], v[156:163], v176
    v_exp_f32 v114, v62
    v_exp_f32 v115, v63
    v_exp_f32 v116, v64
    v_exp_f32 v117, v65
    v_exp_f32 v118, v66
    v_exp_f32 v119, v67
    v_exp_f32 v120, v68
    v_exp_f32 v121, v69
    s_setprio 3
    v_fmac_f32 v20, v20, v106
    v_fmac_f32 v21, v21, v107
    v_fmac_f32 v22, v22, v108
    v_fmac_f32 v23, v23, v109
    v_fmac_f32 v24, v24, v110
    v_fmac_f32 v25, v25, v111
    v_fmac_f32 v26, v26, v112
    v_fmac_f32 v27, v27, v113
    v_fmac_f32 v28, v28, v114
    v_fmac_f32 v29, v29, v115
    v_fmac_f32 v30, v30, v116
    v_fmac_f32 v31, v31, v117
    v_fmac_f32 v32, v32, v118
    v_fmac_f32 v33, v33, v119
    v_fmac_f32 v34, v34, v120
    v_fmac_f32 v35, v35, v121
    v_fmac_f32 v20, v54, v88
    v_fmac_f32 v21, v55, v89
    v_fmac_f32 v22, v56, v90
    v_fmac_f32 v23, v57, v91
    v_fmac_f32 v24, v58, v92
    v_fmac_f32 v25, v59, v93
    v_fmac_f32 v26, v60, v94
    v_fmac_f32 v27, v61, v95
    v_fmac_f32 v28, v62, v96
    v_fmac_f32 v29, v63, v97
    v_fmac_f32 v30, v64, v98
    v_fmac_f32 v31, v65, v99
    v_fmac_f32 v32, v66, v100
    v_fmac_f32 v33, v67, v101
    v_fmac_f32 v34, v68, v102
    v_fmac_f32 v35, v69, v103
    v_fmac_f32 v88, v88, v106
    v_fmac_f32 v89, v89, v107
    v_fmac_f32 v90, v90, v108
    v_fmac_f32 v91, v91, v109
    v_fmac_f32 v92, v92, v110
    v_fmac_f32 v93, v93, v111
    v_fmac_f32 v94, v94, v112
    v_fmac_f32 v95, v95, v113
    v_fmac_f32 v96, v96, v114
    v_fmac_f32 v97, v97, v115
    v_fmac_f32 v98, v98, v116
    v_fmac_f32 v99, v99, v117
    v_fmac_f32 v100, v100, v118
    v_fmac_f32 v101, v101, v119
    v_fmac_f32 v102, v102, v120
    v_fmac_f32 v103, v103, v121
    s_mov_b64 exec, -1
    s_waitcnt vmcnt(0) lgkmcnt(0)
    s_mov_b64 exec, s[74:75]
    s_setprio 1
    v_exp_f32 v106, v38
    v_exp_f32 v107, v39
    v_exp_f32 v108, v40
    v_mfma_f32_32x32x8_bf16 v[54:69], v[182:183], v[186:187], v[140:155]
    v_exp_f32 v109, v41
    v_exp_f32 v110, v42
    v_exp_f32 v111, v43
    v_exp_f32 v112, v44
    v_exp_f32 v113, v45
    v_smfmac_f32_32x32x32_bf16 v[54:69], v[172:175], v[164:171], v176
    v_exp_f32 v114, v46
    v_exp_f32 v115, v47
    v_exp_f32 v116, v48
    v_exp_f32 v117, v49
    v_exp_f32 v118, v50
    v_exp_f32 v119, v51
    v_exp_f32 v120, v52
    v_exp_f32 v121, v53
    s_setprio 3
    v_fmac_f32 v4, v4, v106
    v_fmac_f32 v5, v5, v107
    v_fmac_f32 v6, v6, v108
    v_fmac_f32 v7, v7, v109
    v_fmac_f32 v8, v8, v110
    v_fmac_f32 v9, v9, v111
    v_fmac_f32 v10, v10, v112
    v_fmac_f32 v11, v11, v113
    v_fmac_f32 v12, v12, v114
    v_fmac_f32 v13, v13, v115
    v_fmac_f32 v14, v14, v116
    v_fmac_f32 v15, v15, v117
    v_fmac_f32 v16, v16, v118
    v_fmac_f32 v17, v17, v119
    v_fmac_f32 v18, v18, v120
    v_fmac_f32 v19, v19, v121
    v_fmac_f32 v4, v38, v72
    v_fmac_f32 v5, v39, v73
    v_fmac_f32 v6, v40, v74
    v_fmac_f32 v7, v41, v75
    v_fmac_f32 v8, v42, v76
    v_fmac_f32 v9, v43, v77
    v_fmac_f32 v10, v44, v78
    v_fmac_f32 v11, v45, v79
    v_fmac_f32 v12, v46, v80
    v_fmac_f32 v13, v47, v81
    v_fmac_f32 v14, v48, v82
    v_fmac_f32 v15, v49, v83
    v_fmac_f32 v16, v50, v84
    v_fmac_f32 v17, v51, v85
    v_fmac_f32 v18, v52, v86
    v_fmac_f32 v19, v53, v87
    v_fmac_f32 v72, v72, v106
    v_fmac_f32 v73, v73, v107
    v_fmac_f32 v74, v74, v108
    v_fmac_f32 v75, v75, v109
    v_fmac_f32 v76, v76, v110
    v_fmac_f32 v77, v77, v111
    v_fmac_f32 v78, v78, v112
    v_fmac_f32 v79, v79, v113
    v_fmac_f32 v80, v80, v114
    v_fmac_f32 v81, v81, v115
    v_fmac_f32 v82, v82, v116
    v_fmac_f32 v83, v83, v117
    v_fmac_f32 v84, v84, v118
    v_fmac_f32 v85, v85, v119
    v_fmac_f32 v86, v86, v120
    v_fmac_f32 v87, v87, v121
    s_mov_b64 exec, -1
    v_mul_f32 v38, v72, v73
    v_mul_f32 v39, v74, v75
    v_mul_f32 v40, v76, v77
    v_mul_f32 v41, v78, v79
    v_mul_f32 v42, v80, v81
    v_mul_f32 v43, v82, v83
    v_mul_f32 v44, v84, v85
    v_mul_f32 v45, v86, v87
    v_mul_f32 v4, v4, v73
    v_mul_f32 v5, v5, v72
    v_mul_f32 v6, v6, v75
    v_mul_f32 v7, v7, v74
    v_mul_f32 v8, v8, v77
    v_mul_f32 v9, v9, v76
    v_mul_f32 v10, v10, v79
    v_mul_f32 v11, v11, v78
    v_mul_f32 v12, v12, v81
    v_mul_f32 v13, v13, v80
    v_mul_f32 v14, v14, v83
    v_mul_f32 v15, v15, v82
    v_mul_f32 v16, v16, v85
    v_mul_f32 v17, v17, v84
    v_mul_f32 v18, v18, v87
    v_mul_f32 v19, v19, v86
    v_add_f32 v250, v250, v38
    v_add_f32 v250, v250, v39
    v_add_f32 v250, v250, v40
    v_add_f32 v250, v250, v41
    v_add_f32 v250, v250, v42
    v_add_f32 v250, v250, v43
    v_add_f32 v250, v250, v44
    v_add_f32 v250, v250, v45
    s_mov_b64 exec, -1
    s_setprio 1
    v_rcp_f32 v38, v38
    v_rcp_f32 v39, v39
    v_rcp_f32 v40, v40
    v_rcp_f32 v41, v41
    v_rcp_f32 v42, v42
    v_rcp_f32 v43, v43
    v_rcp_f32 v44, v44
    v_rcp_f32 v45, v45
    v_exp_f32 v106, v54
    v_exp_f32 v107, v55
    v_exp_f32 v108, v56
    v_exp_f32 v109, v57
    v_exp_f32 v110, v58
    v_exp_f32 v111, v59
    v_exp_f32 v112, v60
    v_exp_f32 v113, v61
    v_exp_f32 v114, v62
    v_exp_f32 v115, v63
    v_exp_f32 v116, v64
    v_exp_f32 v117, v65
    v_exp_f32 v118, v66
    v_exp_f32 v119, v67
    v_exp_f32 v120, v68
    v_exp_f32 v121, v69
    s_setprio 3
    v_mul_f32 v4, v4, v38
    v_mul_f32 v5, v5, v38
    v_mul_f32 v6, v6, v39
    v_mul_f32 v7, v7, v39
    v_mul_f32 v8, v8, v40
    v_mul_f32 v9, v9, v40
    v_mul_f32 v10, v10, v41
    v_mul_f32 v11, v11, v41
    v_mul_f32 v12, v12, v42
    v_mul_f32 v13, v13, v42
    v_mul_f32 v14, v14, v43
    v_mul_f32 v15, v15, v43
    v_mul_f32 v16, v16, v44
    v_mul_f32 v17, v17, v44
    v_mul_f32 v18, v18, v45
    v_mul_f32 v19, v19, v45
    s_mov_b64 exec, s[74:75]
    v_fmac_f32 v20, v20, v106
    v_fmac_f32 v21, v21, v107
    v_fmac_f32 v22, v22, v108
    v_fmac_f32 v23, v23, v109
    v_fmac_f32 v24, v24, v110
    v_fmac_f32 v25, v25, v111
    v_fmac_f32 v26, v26, v112
    v_fmac_f32 v27, v27, v113
    v_fmac_f32 v28, v28, v114
    v_fmac_f32 v29, v29, v115
    v_fmac_f32 v30, v30, v116
    v_fmac_f32 v31, v31, v117
    v_fmac_f32 v32, v32, v118
    v_fmac_f32 v33, v33, v119
    v_fmac_f32 v34, v34, v120
    v_fmac_f32 v35, v35, v121
    v_fmac_f32 v20, v54, v88
    v_fmac_f32 v21, v55, v89
    v_fmac_f32 v22, v56, v90
    v_fmac_f32 v23, v57, v91
    v_fmac_f32 v24, v58, v92
    v_fmac_f32 v25, v59, v93
    v_fmac_f32 v26, v60, v94
    v_fmac_f32 v27, v61, v95
    v_fmac_f32 v28, v62, v96
    v_fmac_f32 v29, v63, v97
    v_fmac_f32 v30, v64, v98
    v_fmac_f32 v31, v65, v99
    v_fmac_f32 v32, v66, v100
    v_fmac_f32 v33, v67, v101
    v_fmac_f32 v34, v68, v102
    v_fmac_f32 v35, v69, v103
    v_fmac_f32 v88, v88, v106
    v_fmac_f32 v89, v89, v107
    v_fmac_f32 v90, v90, v108
    v_fmac_f32 v91, v91, v109
    v_fmac_f32 v92, v92, v110
    v_fmac_f32 v93, v93, v111
    v_fmac_f32 v94, v94, v112
    v_fmac_f32 v95, v95, v113
    v_fmac_f32 v96, v96, v114
    v_fmac_f32 v97, v97, v115
    v_fmac_f32 v98, v98, v116
    v_fmac_f32 v99, v99, v117
    v_fmac_f32 v100, v100, v118
    v_fmac_f32 v101, v101, v119
    v_fmac_f32 v102, v102, v120
    v_fmac_f32 v103, v103, v121
    s_mov_b64 exec, -1
    v_mul_f32 v54, v88, v89
    v_mul_f32 v55, v90, v91
    v_mul_f32 v56, v92, v93
    v_mul_f32 v57, v94, v95
    v_mul_f32 v58, v96, v97
    v_mul_f32 v59, v98, v99
    v_mul_f32 v60, v100, v101
    v_mul_f32 v61, v102, v103
    v_mul_f32 v20, v20, v89
    v_mul_f32 v21, v21, v88
    v_mul_f32 v22, v22, v91
    v_mul_f32 v23, v23, v90
    v_mul_f32 v24, v24, v93
    v_mul_f32 v25, v25, v92
    v_mul_f32 v26, v26, v95
    v_mul_f32 v27, v27, v94
    v_mul_f32 v28, v28, v97
    v_mul_f32 v29, v29, v96
    v_mul_f32 v30, v30, v99
    v_mul_f32 v31, v31, v98
    v_mul_f32 v32, v32, v101
    v_mul_f32 v33, v33, v100
    v_mul_f32 v34, v34, v103
    v_mul_f32 v35, v35, v102
    v_add_f32 v250, v250, v54
    v_add_f32 v250, v250, v55
    v_add_f32 v250, v250, v56
    v_add_f32 v250, v250, v57
    v_add_f32 v250, v250, v58
    v_add_f32 v250, v250, v59
    v_add_f32 v250, v250, v60
    v_add_f32 v250, v250, v61
    s_setprio 1
    v_rcp_f32 v54, v54
    v_rcp_f32 v55, v55
    v_rcp_f32 v56, v56
    v_rcp_f32 v57, v57
    v_rcp_f32 v58, v58
    v_rcp_f32 v59, v59
    v_rcp_f32 v60, v60
    v_rcp_f32 v61, v61
    v_cvt_pk_bf16_f32 v46, v4, v5
    v_cvt_pk_bf16_f32 v47, v6, v7
    v_cvt_pk_bf16_f32 v48, v8, v9
    v_cvt_pk_bf16_f32 v49, v10, v11
    ds_write_b128 v238, v[46:49]
    v_cvt_pk_bf16_f32 v50, v12, v13
    v_cvt_pk_bf16_f32 v51, v14, v15
    v_cvt_pk_bf16_f32 v52, v16, v17
    v_cvt_pk_bf16_f32 v53, v18, v19
    ds_write_b128 v239, v[50:53]
    s_setprio 3
    v_mul_f32 v20, v20, v54
    v_mul_f32 v21, v21, v54
    v_mul_f32 v22, v22, v55
    v_mul_f32 v23, v23, v55
    v_mul_f32 v24, v24, v56
    v_mul_f32 v25, v25, v56
    v_mul_f32 v26, v26, v57
    v_mul_f32 v27, v27, v57
    v_mul_f32 v28, v28, v58
    v_mul_f32 v29, v29, v58
    v_mul_f32 v30, v30, v59
    v_mul_f32 v31, v31, v59
    v_mul_f32 v32, v32, v60
    v_mul_f32 v33, v33, v60
    v_mul_f32 v34, v34, v61
    v_mul_f32 v35, v35, v61
    v_cmp_ngt_f32 vcc, 0x6c800000, v250
    v_cvt_pk_bf16_f32 v62, v20, v21
    v_cvt_pk_bf16_f32 v63, v22, v23
    v_cvt_pk_bf16_f32 v64, v24, v25
    v_cvt_pk_bf16_f32 v65, v26, v27
    ds_write_b128 v240, v[62:65]
    v_cvt_pk_bf16_f32 v66, v28, v29
    v_cvt_pk_bf16_f32 v67, v30, v31
    v_cvt_pk_bf16_f32 v68, v32, v33
    v_cvt_pk_bf16_f32 v69, v34, v35
    ds_write_b128 v241, v[66:69]
K_FLUSHED:
    s_setprio 0
    s_cbranch_vccnz K_FLAG
K_JOIN:
    v_mov_b32 v252, 0
    s_add_u32 s94, s82, s83
    s_waitcnt lgkmcnt(0)
    s_barrier
    ds_read_b64 v[178:179], v252 offset:24568
    s_cmp_ge_u32 s80, 4
    s_cbranch_scc1 K_NEXT
K_TAIL:
    ds_read_b64_tr_b16 v[40:41], v242 offset:0
    ds_read_b64_tr_b16 v[42:43], v244 offset:512
    ds_read_b64_tr_b16 v[44:45], v243 offset:0
    ds_read_b64_tr_b16 v[46:47], v245 offset:512
    ds_read_b64_tr_b16 v[48:49], v244 offset:0
    ds_read_b64_tr_b16 v[50:51], v242 offset:512
    ds_read_b64_tr_b16 v[52:53], v245 offset:0
    ds_read_b64_tr_b16 v[54:55], v243 offset:512
    ds_read_b64_tr_b16 v[56:57], v242 offset:4096
    ds_read_b64_tr_b16 v[58:59], v244 offset:4608
    ds_read_b64_tr_b16 v[60:61], v243 offset:4096
    ds_read_b64_tr_b16 v[62:63], v245 offset:4608
    ds_read_b64_tr_b16 v[64:65], v244 offset:4096
    ds_read_b64_tr_b16 v[66:67], v242 offset:4608
    s_waitcnt lgkmcnt(10)
    v_mfma_f32_16x16x32_bf16 v[8:11], v[40:43], v[220:223], 0
    ds_read_b64_tr_b16 v[68:69], v245 offset:4096
    ds_read_b64_tr_b16 v[70:71], v243 offset:4608
    v_mfma_f32_16x16x32_bf16 v[12:15], v[44:47], v[220:223], 0
    ds_read_b64_tr_b16 v[72:73], v242 offset:8192
    s_waitcnt lgkmcnt(9)
    v_mfma_f32_16x16x32_bf16 v[16:19], v[48:51], v[220:223], 0
    ds_read_b64_tr_b16 v[74:75], v244 offset:8704
    ds_read_b64_tr_b16 v[76:77], v243 offset:8192
    v_mfma_f32_16x16x32_bf16 v[20:23], v[52:55], v[220:223], 0
    ds_read_b64_tr_b16 v[78:79], v245 offset:8704
    s_waitcnt lgkmcnt(8)
    v_mfma_f32_16x16x32_bf16 v[8:11], v[56:59], v[224:227], v[8:11]
    ds_read_b64_tr_b16 v[80:81], v244 offset:8192
    ds_read_b64_tr_b16 v[82:83], v242 offset:8704
    v_mfma_f32_16x16x32_bf16 v[12:15], v[60:63], v[224:227], v[12:15]
    ds_read_b64_tr_b16 v[84:85], v245 offset:8192
    s_waitcnt lgkmcnt(7)
    v_mfma_f32_16x16x32_bf16 v[16:19], v[64:67], v[224:227], v[16:19]
    ds_read_b64_tr_b16 v[86:87], v243 offset:8704
    v_readfirstlane_b32 s93, v179
    v_mfma_f32_16x16x32_bf16 v[20:23], v[68:71], v[224:227], v[20:23]
    v_readfirstlane_b32 s92, v178
    s_waitcnt lgkmcnt(4)
    v_mfma_f32_16x16x32_bf16 v[8:11], v[72:75], v[228:231], v[8:11]
    s_add_u32 s87, s87, 6
    s_lshl_b32 s95, s87, 4
    v_mfma_f32_16x16x32_bf16 v[12:15], v[76:79], v[228:231], v[12:15]
    s_cmp_eq_u32 s93, 0
    s_waitcnt lgkmcnt(0)
    v_mfma_f32_16x16x32_bf16 v[16:19], v[80:83], v[228:231], v[16:19]
    s_cbranch_scc1 K_TOSAFE
    s_cmp_gt_u32 s88, s95
    v_mfma_f32_16x16x32_bf16 v[20:23], v[84:87], v[228:231], v[20:23]
    v_cvt_pk_bf16_f32 v24, v8, v9
    v_cvt_pk_bf16_f32 v25, v10, v11
    v_cvt_pk_bf16_f32 v26, v12, v13
    v_cvt_pk_bf16_f32 v27, v14, v15
    s_cselect_b32 s92, 0, s92
    v_cvt_pk_bf16_f32 v28, v16, v17
    v_mfma_f32_16x16x32_bf16 v[204:207], v[124:127], v[24:27], v[204:207]
    v_cvt_pk_bf16_f32 v29, v18, v19
    v_cvt_pk_bf16_f32 v30, v20, v21
    v_mfma_f32_16x16x32_bf16 v[208:211], v[132:135], v[24:27], v[208:211]
    v_cvt_pk_bf16_f32 v31, v22, v23
    s_cmp_lt_u32 s94, 256
    v_mfma_f32_16x16x32_bf16 v[212:215], v[140:143], v[24:27], v[212:215]
    s_cselect_b32 s92, 0, s92
    v_mfma_f32_16x16x32_bf16 v[204:207], v[128:131], v[28:31], v[204:207]
    s_cmp_eq_u32 s92, 0
    v_mov_b32 v252, 0xbfb8aa3b
    v_mfma_f32_16x16x32_bf16 v[208:211], v[136:139], v[28:31], v[208:211]
    s_nop 0
    v_mfma_f32_16x16x32_bf16 v[216:219], v[148:151], v[24:27], v[216:219]
    s_nop 0
    v_mfma_f32_16x16x32_bf16 v[212:215], v[144:147], v[28:31], v[212:215]
    v_mfma_f32_16x16x32_bf16 v[216:219], v[152:155], v[28:31], v[216:219]
    s_cbranch_scc1 K_SLOW
K_OUT:
    v_exp_f32 v40, v204
    v_exp_f32 v41, v205
    v_exp_f32 v42, v206
    v_exp_f32 v43, v207
    v_exp_f32 v44, v208
    v_exp_f32 v45, v209
    v_exp_f32 v46, v210
    v_exp_f32 v47, v211
    v_pk_fma_f32 v[40:41], v[40:41], v[252:253], v[252:253] op_sel_hi:[1,0,0]
    v_pk_fma_f32 v[42:43], v[42:43], v[252:253], v[252:253] op_sel_hi:[1,0,0]
    v_pk_fma_f32 v[44:45], v[44:45], v[252:253], v[252:253] op_sel_hi:[1,0,0]
    v_pk_fma_f32 v[46:47], v[46:47], v[252:253], v[252:253] op_sel_hi:[1,0,0]
    v_rcp_f32 v40, v40
    v_rcp_f32 v41, v41
    v_rcp_f32 v42, v42
    v_rcp_f32 v43, v43
    v_rcp_f32 v44, v44
    v_rcp_f32 v45, v45
    v_rcp_f32 v46, v46
    v_rcp_f32 v47, v47
    v_pk_mul_f32 v[40:41], v[40:41], v[204:205]
    v_pk_mul_f32 v[42:43], v[42:43], v[206:207]
    v_pk_mul_f32 v[44:45], v[44:45], v[208:209]
    v_pk_mul_f32 v[46:47], v[46:47], v[210:211]
    v_cvt_pk_bf16_f32 v8, v40, v41
    v_cvt_pk_bf16_f32 v9, v42, v43
    v_cvt_pk_bf16_f32 v10, v44, v45
    v_cvt_pk_bf16_f32 v11, v46, v47
    s_mov_b64 exec, s[90:91]
    buffer_store_dwordx4 v[8:11], v247, s[32:35], 0 offen offset:0 sc1
    v_exp_f32 v48, v212
    v_exp_f32 v49, v213
    v_exp_f32 v50, v214
    v_exp_f32 v51, v215
    v_exp_f32 v52, v216
    v_exp_f32 v53, v217
    v_exp_f32 v54, v218
    v_exp_f32 v55, v219
    v_pk_fma_f32 v[48:49], v[48:49], v[252:253], v[252:253] op_sel_hi:[1,0,0]
    v_pk_fma_f32 v[50:51], v[50:51], v[252:253], v[252:253] op_sel_hi:[1,0,0]
    v_pk_fma_f32 v[52:53], v[52:53], v[252:253], v[252:253] op_sel_hi:[1,0,0]
    v_pk_fma_f32 v[54:55], v[54:55], v[252:253], v[252:253] op_sel_hi:[1,0,0]
    v_rcp_f32 v48, v48
    v_rcp_f32 v49, v49
    v_rcp_f32 v50, v50
    v_rcp_f32 v51, v51
    v_rcp_f32 v52, v52
    v_rcp_f32 v53, v53
    v_rcp_f32 v54, v54
    v_rcp_f32 v55, v55
    v_pk_mul_f32 v[48:49], v[48:49], v[212:213]
    v_pk_mul_f32 v[50:51], v[50:51], v[214:215]
    v_pk_mul_f32 v[52:53], v[52:53], v[216:217]
    v_pk_mul_f32 v[54:55], v[54:55], v[218:219]
    v_cvt_pk_bf16_f32 v12, v48, v49
    v_cvt_pk_bf16_f32 v13, v50, v51
    v_cvt_pk_bf16_f32 v14, v52, v53
    v_cvt_pk_bf16_f32 v15, v54, v55
    buffer_store_dwordx4 v[12:15], v247, s[32:35], 0 offen offset:64 sc1
K_END:
    s_endpgm
K_SLOW:
    s_cmp_gt_u32 s88, s95
    s_cbranch_scc0 K_NEXT
    v_and_b32 v252, 0xffff, v248
    v_max_u32 v252, s95, v252
    v_and_b32 v248, 0xffff0000, v248
    v_or_b32 v248, v248, v252
    s_min_u32 s87, s87, 10
    v_lshrrev_b32 v251, 1, v1
    s_lshl_b32 s92, s87, 4
    v_and_b32 v251, 24, v251
    v_add_u32 v251, s92, v251
    v_and_b32 v252, 0xffff, v248
    v_lshrrev_b32 v253, 16, v248
    v_sub_u32 v252, v252, v251
    v_sub_u32 v253, v253, v251
    v_med3_i32 v254, v252, 0, 8
    v_med3_i32 v255, v253, 0, 8
    v_mad_u32_u24 v254, v254, 9, v255
    v_lshlrev_b32 v254, 4, v254
    ds_read_b128 v[220:223], v254 offset:1280
    v_subrev_u32 v252, 32, v252
    v_subrev_u32 v253, 32, v253
    v_med3_i32 v254, v252, 0, 8
    v_med3_i32 v255, v253, 0, 8
    v_mad_u32_u24 v254, v254, 9, v255
    v_lshlrev_b32 v254, 4, v254
    ds_read_b128 v[224:227], v254 offset:1280
    v_subrev_u32 v252, 32, v252
    v_subrev_u32 v253, 32, v253
    v_med3_i32 v254, v252, 0, 8
    v_med3_i32 v255, v253, 0, 8
    v_mad_u32_u24 v254, v254, 9, v255
    v_lshlrev_b32 v254, 4, v254
    ds_read_b128 v[228:231], v254 offset:1280
    s_lshl_b32 s92, s87, 11
    s_add_u32 s92, s92, 90112
    v_add_u32 v242, s92, v123
    v_xor_b32 v243, 32, v242
    v_xor_b32 v244, 64, v242
    v_xor_b32 v245, 96, v242
    s_waitcnt lgkmcnt(0)
    s_branch K_TAIL
K_NEXT:
    s_waitcnt lgkmcnt(0)
    v_readfirstlane_b32 s92, v178
    v_readfirstlane_b32 s93, v179
    s_nop 0
    s_cmp_eq_u32 s93, 0
    s_cbranch_scc1 K_TOSAFE
    s_mov_b32 s82, s94
    s_cmp_lt_u32 s94, 256
    s_cbranch_scc1 K_AGAIN
    s_mov_b32 s82, 0
    s_add_u32 s81, s81, 128
    s_cmp_eq_u32 s92, 0
    s_cbranch_scc1 K_AGAIN
    s_cmp_lg_u32 s2, 0
    s_cbranch_scc1 K_END
    s_cmp_lg_u32 s80, 4
    s_cbranch_scc1 K_END
    s_add_u32 s36, s14, 13107200
    s_addc_u32 s37, s15, 0
    s_mov_b32 s38, 4
    s_mov_b32 s39, 0x00020000
    v_sub_u32 v253, 0, v1
    v_xor_b32 v253, s89, v253
    v_lshlrev_b32 v252, 2, v1
    buffer_store_dword v253, v252, s[36:39], 0 offen sc1
    s_endpgm
.p2align 12
K_STA3:
    s_setpc_b64 s[0:1]
K_L15A:
    s_mov_b64 exec, -1
    s_waitcnt vmcnt(0) lgkmcnt(0)
    s_add_u32 m0, s86, 0
    ds_read_b128 v[156:159], v200 offset:32768
    ds_read_b128 v[160:163], v201 offset:32768
    ds_read_b64 v[186:187], v237 offset:24576
    buffer_load_dwordx4 v[188:189], s[28:31], 0 idxen offen offset:0 sc1 lds
    buffer_load_dwordx4 v[190:191], s[28:31], 0 idxen offen offset:1024 sc1 lds
    buffer_load_dwordx4 v[192:193], s[28:31], 0 idxen offen offset:2048 sc1 lds
    buffer_load_dwordx4 v[194:195], s[28:31], 0 idxen offen offset:3072 sc1 lds
    s_mov_b64 exec, s[70:71]
    v_fmac_f32 v20, v20, v106
    v_fmac_f32 v21, v21, v107
    v_fmac_f32 v22, v22, v108
    v_fmac_f32 v23, v23, v109
    v_fmac_f32 v24, v24, v110
    v_fmac_f32 v25, v25, v111
    v_fmac_f32 v26, v26, v112
    v_fmac_f32 v27, v27, v113
    v_fmac_f32 v28, v28, v114
    v_fmac_f32 v29, v29, v115
    v_fmac_f32 v30, v30, v116
    v_fmac_f32 v31, v31, v117
    v_fmac_f32 v32, v32, v118
    v_fmac_f32 v33, v33, v119
    v_fmac_f32 v34, v34, v120
    v_fmac_f32 v35, v35, v121
    v_fmac_f32 v20, v54, v88
    v_fmac_f32 v21, v55, v89
    v_fmac_f32 v22, v56, v90
    v_fmac_f32 v23, v57, v91
    v_fmac_f32 v24, v58, v92
    v_fmac_f32 v25, v59, v93
    v_fmac_f32 v26, v60, v94
    v_fmac_f32 v27, v61, v95
    v_fmac_f32 v28, v62, v96
    v_fmac_f32 v29, v63, v97
    v_fmac_f32 v30, v64, v98
    v_fmac_f32 v31, v65, v99
    v_fmac_f32 v32, v66, v100
    v_fmac_f32 v33, v67, v101
    v_fmac_f32 v34, v68, v102
    v_fmac_f32 v35, v69, v103
    v_fmac_f32 v88, v88, v106
    v_fmac_f32 v89, v89, v107
    v_fmac_f32 v90, v90, v108
    v_fmac_f32 v91, v91, v109
    v_fmac_f32 v92, v92, v110
    v_fmac_f32 v93, v93, v111
    v_fmac_f32 v94, v94, v112
    v_fmac_f32 v95, v95, v113
    v_fmac_f32 v96, v96, v114
    v_fmac_f32 v97, v97, v115
    v_fmac_f32 v98, v98, v116
    v_fmac_f32 v99, v99, v117
    v_fmac_f32 v100, v100, v118
    v_fmac_f32 v101, v101, v119
    v_fmac_f32 v102, v102, v120
    v_fmac_f32 v103, v103, v121
    s_setprio 2
    v_exp_f32 v106, v38
    v_exp_f32 v107, v39
    v_exp_f32 v108, v40
    v_mfma_f32_32x32x8_bf16 v[54:69], v[182:183], v[184:185], v[140:155]
    v_exp_f32 v109, v41
    v_exp_f32 v110, v42
    v_exp_f32 v111, v43
    v_exp_f32 v112, v44
    v_exp_f32 v113, v45
    v_smfmac_f32_32x32x32_bf16 v[54:69], v[172:175], v[164:171], v176
    v_exp_f32 v114, v46
    v_exp_f32 v115, v47
    v_exp_f32 v116, v48
    v_exp_f32 v117, v49
    v_exp_f32 v118, v50
    v_exp_f32 v119, v51
    v_exp_f32 v120, v52
    v_exp_f32 v121, v53
    s_setprio 0
    s_mov_b64 exec, -1
    s_waitcnt lgkmcnt(0)
    ds_read_b128 v[164:167], v202 offset:32768
    ds_read_b128 v[168:171], v203 offset:32768
    ds_read_u16 v237, v236 offset:58
    s_mov_b64 exec, s[72:73]
    v_fmac_f32 v4, v4, v106
    v_fmac_f32 v5, v5, v107
    v_fmac_f32 v6, v6, v108
    v_fmac_f32 v7, v7, v109
    v_fmac_f32 v8, v8, v110
    v_fmac_f32 v9, v9, v111
    v_fmac_f32 v10, v10, v112
    v_fmac_f32 v11, v11, v113
    v_fmac_f32 v12, v12, v114
    v_fmac_f32 v13, v13, v115
    v_fmac_f32 v14, v14, v116
    v_fmac_f32 v15, v15, v117
    v_fmac_f32 v16, v16, v118
    v_fmac_f32 v17, v17, v119
    v_fmac_f32 v18, v18, v120
    v_fmac_f32 v19, v19, v121
    v_fmac_f32 v4, v38, v72
    v_fmac_f32 v5, v39, v73
    v_fmac_f32 v6, v40, v74
    v_fmac_f32 v7, v41, v75
    v_fmac_f32 v8, v42, v76
    v_fmac_f32 v9, v43, v77
    v_fmac_f32 v10, v44, v78
    v_fmac_f32 v11, v45, v79
    v_fmac_f32 v12, v46, v80
    v_fmac_f32 v13, v47, v81
    v_fmac_f32 v14, v48, v82
    v_fmac_f32 v15, v49, v83
    v_fmac_f32 v16, v50, v84
    v_fmac_f32 v17, v51, v85
    v_fmac_f32 v18, v52, v86
    v_fmac_f32 v19, v53, v87
    v_fmac_f32 v72, v72, v106
    v_fmac_f32 v73, v73, v107
    v_fmac_f32 v74, v74, v108
    v_fmac_f32 v75, v75, v109
    v_fmac_f32 v76, v76, v110
    v_fmac_f32 v77, v77, v111
    v_fmac_f32 v78, v78, v112
    v_fmac_f32 v79, v79, v113
    v_fmac_f32 v80, v80, v114
    v_fmac_f32 v81, v81, v115
    v_fmac_f32 v82, v82, v116
    v_fmac_f32 v83, v83, v117
    v_fmac_f32 v84, v84, v118
    v_fmac_f32 v85, v85, v119
    v_fmac_f32 v86, v86, v120
    v_fmac_f32 v87, v87, v121
    s_setprio 2
    v_exp_f32 v106, v54
    v_exp_f32 v107, v55
    v_exp_f32 v108, v56
    v_mfma_f32_32x32x8_bf16 v[38:53], v[180:181], v[186:187], v[124:139]
    v_exp_f32 v109, v57
    v_exp_f32 v110, v58
    v_exp_f32 v111, v59
    v_exp_f32 v112, v60
    v_exp_f32 v113, v61
    v_smfmac_f32_32x32x32_bf16 v[38:53], v[172:175], v[156:163], v176
    v_exp_f32 v114, v62
    v_exp_f32 v115, v63
    v_exp_f32 v116, v64
    v_exp_f32 v117, v65
    v_exp_f32 v118, v66
    v_exp_f32 v119, v67
    v_exp_f32 v120, v68
    v_exp_f32 v121, v69
    s_setprio 0
    s_mov_b64 exec, -1
    s_waitcnt vmcnt(0) lgkmcnt(0)
    ds_read_b128 v[156:159], v200 offset:0
    ds_read_b128 v[160:163], v201 offset:0
    ds_read_b64 v[184:185], v237 offset:24576
    s_mov_b64 exec, s[72:73]
    v_fmac_f32 v20, v20, v106
    v_fmac_f32 v21, v21, v107
    v_fmac_f32 v22, v22, v108
    v_fmac_f32 v23, v23, v109
    v_fmac_f32 v24, v24, v110
    v_fmac_f32 v25, v25, v111
    v_fmac_f32 v26, v26, v112
    v_fmac_f32 v27, v27, v113
    v_fmac_f32 v28, v28, v114
    v_fmac_f32 v29, v29, v115
    v_fmac_f32 v30, v30, v116
    v_fmac_f32 v31, v31, v117
    v_fmac_f32 v32, v32, v118
    v_fmac_f32 v33, v33, v119
    v_fmac_f32 v34, v34, v120
    v_fmac_f32 v35, v35, v121
    v_fmac_f32 v20, v54, v88
    v_fmac_f32 v21, v55, v89
    v_fmac_f32 v22, v56, v90
    v_fmac_f32 v23, v57, v91
    v_fmac_f32 v24, v58, v92
    v_fmac_f32 v25, v59, v93
    v_fmac_f32 v26, v60, v94
    v_fmac_f32 v27, v61, v95
    v_fmac_f32 v28, v62, v96
    v_fmac_f32 v29, v63, v97
    v_fmac_f32 v30, v64, v98
    v_fmac_f32 v31, v65, v99
    v_fmac_f32 v32, v66, v100
    v_fmac_f32 v33, v67, v101
    v_fmac_f32 v34, v68, v102
    v_fmac_f32 v35, v69, v103
    v_fmac_f32 v88, v88, v106
    v_fmac_f32 v89, v89, v107
    v_fmac_f32 v90, v90, v108
    v_fmac_f32 v91, v91, v109
    v_fmac_f32 v92, v92, v110
    v_fmac_f32 v93, v93, v111
    v_fmac_f32 v94, v94, v112
    v_fmac_f32 v95, v95, v113
    v_fmac_f32 v96, v96, v114
    v_fmac_f32 v97, v97, v115
    v_fmac_f32 v98, v98, v116
    v_fmac_f32 v99, v99, v117
    v_fmac_f32 v100, v100, v118
    v_fmac_f32 v101, v101, v119
    v_fmac_f32 v102, v102, v120
    v_fmac_f32 v103, v103, v121
    s_setprio 2
    v_exp_f32 v106, v38
    v_exp_f32 v107, v39
    v_exp_f32 v108, v40
    v_mfma_f32_32x32x8_bf16 v[54:69], v[182:183], v[186:187], v[140:155]
    v_exp_f32 v109, v41
    v_exp_f32 v110, v42
    v_exp_f32 v111, v43
    v_exp_f32 v112, v44
    v_exp_f32 v113, v45
    v_smfmac_f32_32x32x32_bf16 v[54:69], v[172:175], v[164:171], v176
    v_exp_f32 v114, v46
    v_exp_f32 v115, v47
    v_exp_f32 v116, v48
    v_exp_f32 v117, v49
    v_exp_f32 v118, v50
    v_exp_f32 v119, v51
    v_exp_f32 v120, v52
    v_exp_f32 v121, v53
    s_setprio 0
    s_mov_b64 exec, -1
    s_waitcnt lgkmcnt(0)
    ds_read_b128 v[164:167], v202 offset:0
    ds_read_b128 v[168:171], v203 offset:0
    s_mov_b64 exec, s[74:75]
    v_fmac_f32 v4, v4, v106
    v_fmac_f32 v5, v5, v107
    v_fmac_f32 v6, v6, v108
    v_fmac_f32 v7, v7, v109
    v_fmac_f32 v8, v8, v110
    v_fmac_f32 v9, v9, v111
    v_fmac_f32 v10, v10, v112
    v_fmac_f32 v11, v11, v113
    v_fmac_f32 v12, v12, v114
    v_fmac_f32 v13, v13, v115
    v_fmac_f32 v14, v14, v116
    v_fmac_f32 v15, v15, v117
    v_fmac_f32 v16, v16, v118
    v_fmac_f32 v17, v17, v119
    v_fmac_f32 v18, v18, v120
    v_fmac_f32 v19, v19, v121
    v_fmac_f32 v4, v38, v72
    v_fmac_f32 v5, v39, v73
    v_fmac_f32 v6, v40, v74
    v_fmac_f32 v7, v41, v75
    v_fmac_f32 v8, v42, v76
    v_fmac_f32 v9, v43, v77
    v_fmac_f32 v10, v44, v78
    v_fmac_f32 v11, v45, v79
    v_fmac_f32 v12, v46, v80
    v_fmac_f32 v13, v47, v81
    v_fmac_f32 v14, v48, v82
    v_fmac_f32 v15, v49, v83
    v_fmac_f32 v16, v50, v84
    v_fmac_f32 v17, v51, v85
    v_fmac_f32 v18, v52, v86
    v_fmac_f32 v19, v53, v87
    v_fmac_f32 v72, v72, v106
    v_fmac_f32 v73, v73, v107
    v_fmac_f32 v74, v74, v108
    v_fmac_f32 v75, v75, v109
    v_fmac_f32 v76, v76, v110
    v_fmac_f32 v77, v77, v111
    v_fmac_f32 v78, v78, v112
    v_fmac_f32 v79, v79, v113
    v_fmac_f32 v80, v80, v114
    v_fmac_f32 v81, v81, v115
    v_fmac_f32 v82, v82, v116
    v_fmac_f32 v83, v83, v117
    v_fmac_f32 v84, v84, v118
    v_fmac_f32 v85, v85, v119
    v_fmac_f32 v86, v86, v120
    v_fmac_f32 v87, v87, v121
    s_setprio 2
    v_exp_f32 v106, v54
    v_exp_f32 v107, v55
    v_exp_f32 v108, v56
    v_mfma_f32_32x32x8_bf16 v[38:53], v[180:181], v[184:185], v[124:139]
    v_exp_f32 v109, v57
    v_exp_f32 v110, v58
    v_exp_f32 v111, v59
    v_exp_f32 v112, v60
    v_exp_f32 v113, v61
    v_smfmac_f32_32x32x32_bf16 v[38:53], v[172:175], v[156:163], v176
    v_exp_f32 v114, v62
    v_exp_f32 v115, v63
    v_exp_f32 v116, v64
    v_exp_f32 v117, v65
    v_exp_f32 v118, v66
    v_exp_f32 v119, v67
    v_exp_f32 v120, v68
    v_exp_f32 v121, v69
    s_setprio 0
    s_mov_b64 exec, -1
    s_waitcnt vmcnt(0) lgkmcnt(0)
    s_mov_b64 exec, s[74:75]
    v_fmac_f32 v20, v20, v106
    v_fmac_f32 v21, v21, v107
    v_fmac_f32 v22, v22, v108
    v_fmac_f32 v23, v23, v109
    v_fmac_f32 v24, v24, v110
    v_fmac_f32 v25, v25, v111
    v_fmac_f32 v26, v26, v112
    v_fmac_f32 v27, v27, v113
    v_fmac_f32 v28, v28, v114
    v_fmac_f32 v29, v29, v115
    v_fmac_f32 v30, v30, v116
    v_fmac_f32 v31, v31, v117
    v_fmac_f32 v32, v32, v118
    v_fmac_f32 v33, v33, v119
    v_fmac_f32 v34, v34, v120
    v_fmac_f32 v35, v35, v121
    v_fmac_f32 v20, v54, v88
    v_fmac_f32 v21, v55, v89
    v_fmac_f32 v22, v56, v90
    v_fmac_f32 v23, v57, v91
    v_fmac_f32 v24, v58, v92
    v_fmac_f32 v25, v59, v93
    v_fmac_f32 v26, v60, v94
    v_fmac_f32 v27, v61, v95
    v_fmac_f32 v28, v62, v96
    v_fmac_f32 v29, v63, v97
    v_fmac_f32 v30, v64, v98
    v_fmac_f32 v31, v65, v99
    v_fmac_f32 v32, v66, v100
    v_fmac_f32 v33, v67, v101
    v_fmac_f32 v34, v68, v102
    v_fmac_f32 v35, v69, v103
    v_fmac_f32 v88, v88, v106
    v_fmac_f32 v89, v89, v107
    v_fmac_f32 v90, v90, v108
    v_fmac_f32 v91, v91, v109
    v_fmac_f32 v92, v92, v110
    v_fmac_f32 v93, v93, v111
    v_fmac_f32 v94, v94, v112
    v_fmac_f32 v95, v95, v113
    v_fmac_f32 v96, v96, v114
    v_fmac_f32 v97, v97, v115
    v_fmac_f32 v98, v98, v116
    v_fmac_f32 v99, v99, v117
    v_fmac_f32 v100, v100, v118
    v_fmac_f32 v101, v101, v119
    v_fmac_f32 v102, v102, v120
    v_fmac_f32 v103, v103, v121
    s_setprio 2
    v_exp_f32 v106, v38
    v_exp_f32 v107, v39
    v_exp_f32 v108, v40
    v_mfma_f32_32x32x8_bf16 v[54:69], v[182:183], v[184:185], v[140:155]
    v_exp_f32 v109, v41
    v_exp_f32 v110, v42
    v_exp_f32 v111, v43
    v_exp_f32 v112, v44
    v_exp_f32 v113, v45
    v_smfmac_f32_32x32x32_bf16 v[54:69], v[172:175], v[164:171], v176
    v_exp_f32 v114, v46
    v_exp_f32 v115, v47
    v_exp_f32 v116, v48
    v_exp_f32 v117, v49
    v_exp_f32 v118, v50
    v_exp_f32 v119, v51
    v_exp_f32 v120, v52
    v_exp_f32 v121, v53
    s_setprio 0
    s_mov_b64 exec, -1
    s_mov_b64 exec, s[76:77]
    v_fmac_f32 v4, v4, v106
    v_fmac_f32 v5, v5, v107
    v_fmac_f32 v6, v6, v108
    v_fmac_f32 v7, v7, v109
    v_fmac_f32 v8, v8, v110
    v_fmac_f32 v9, v9, v111
    v_fmac_f32 v10, v10, v112
    v_fmac_f32 v11, v11, v113
    v_fmac_f32 v12, v12, v114
    v_fmac_f32 v13, v13, v115
    v_fmac_f32 v14, v14, v116
    v_fmac_f32 v15, v15, v117
    v_fmac_f32 v16, v16, v118
    v_fmac_f32 v17, v17, v119
    v_fmac_f32 v18, v18, v120
    v_fmac_f32 v19, v19, v121
    v_fmac_f32 v4, v38, v72
    v_fmac_f32 v5, v39, v73
    v_fmac_f32 v6, v40, v74
    v_fmac_f32 v7, v41, v75
    v_fmac_f32 v8, v42, v76
    v_fmac_f32 v9, v43, v77
    v_fmac_f32 v10, v44, v78
    v_fmac_f32 v11, v45, v79
    v_fmac_f32 v12, v46, v80
    v_fmac_f32 v13, v47, v81
    v_fmac_f32 v14, v48, v82
    v_fmac_f32 v15, v49, v83
    v_fmac_f32 v16, v50, v84
    v_fmac_f32 v17, v51, v85
    v_fmac_f32 v18, v52, v86
    v_fmac_f32 v19, v53, v87
    v_fmac_f32 v72, v72, v106
    v_fmac_f32 v73, v73, v107
    v_fmac_f32 v74, v74, v108
    v_fmac_f32 v75, v75, v109
    v_fmac_f32 v76, v76, v110
    v_fmac_f32 v77, v77, v111
    v_fmac_f32 v78, v78, v112
    v_fmac_f32 v79, v79, v113
    v_fmac_f32 v80, v80, v114
    v_fmac_f32 v81, v81, v115
    v_fmac_f32 v82, v82, v116
    v_fmac_f32 v83, v83, v117
    v_fmac_f32 v84, v84, v118
    v_fmac_f32 v85, v85, v119
    v_fmac_f32 v86, v86, v120
    v_fmac_f32 v87, v87, v121
    s_mov_b64 exec, -1
    v_mul_f32 v38, v72, v73
    v_mul_f32 v39, v74, v75
    v_mul_f32 v40, v76, v77
    v_mul_f32 v41, v78, v79
    v_mul_f32 v42, v80, v81
    v_mul_f32 v43, v82, v83
    v_mul_f32 v44, v84, v85
    v_mul_f32 v45, v86, v87
    v_mul_f32 v4, v4, v73
    v_mul_f32 v5, v5, v72
    v_mul_f32 v6, v6, v75
    v_mul_f32 v7, v7, v74
    v_mul_f32 v8, v8, v77
    v_mul_f32 v9, v9, v76
    v_mul_f32 v10, v10, v79
    v_mul_f32 v11, v11, v78
    v_mul_f32 v12, v12, v81
    v_mul_f32 v13, v13, v80
    v_mul_f32 v14, v14, v83
    v_mul_f32 v15, v15, v82
    v_mul_f32 v16, v16, v85
    v_mul_f32 v17, v17, v84
    v_mul_f32 v18, v18, v87
    v_mul_f32 v19, v19, v86
    v_add_f32 v250, v250, v38
    v_add_f32 v250, v250, v39
    v_add_f32 v250, v250, v40
    v_add_f32 v250, v250, v41
    v_add_f32 v250, v250, v42
    v_add_f32 v250, v250, v43
    v_add_f32 v250, v250, v44
    v_add_f32 v250, v250, v45
    s_setprio 2
    v_rcp_f32 v38, v38
    v_rcp_f32 v39, v39
    v_rcp_f32 v40, v40
    v_rcp_f32 v41, v41
    v_rcp_f32 v42, v42
    v_rcp_f32 v43, v43
    v_rcp_f32 v44, v44
    v_rcp_f32 v45, v45
    v_exp_f32 v106, v54
    v_exp_f32 v107, v55
    v_exp_f32 v108, v56
    v_exp_f32 v109, v57
    v_exp_f32 v110, v58
    v_exp_f32 v111, v59
    v_exp_f32 v112, v60
    v_exp_f32 v113, v61
    v_exp_f32 v114, v62
    v_exp_f32 v115, v63
    v_exp_f32 v116, v64
    v_exp_f32 v117, v65
    v_exp_f32 v118, v66
    v_exp_f32 v119, v67
    v_exp_f32 v120, v68
    v_exp_f32 v121, v69
    ds_read_b64_tr_b16 v[124:125], v246 offset:0
    ds_read_b64_tr_b16 v[126:127], v246 offset:512
    ds_read_b64_tr_b16 v[128:129], v246 offset:4096
    ds_read_b64_tr_b16 v[130:131], v246 offset:4608
    ds_read_b64_tr_b16 v[132:133], v246 offset:8
    ds_read_b64_tr_b16 v[134:135], v246 offset:520
    ds_read_b64_tr_b16 v[136:137], v246 offset:4104
    ds_read_b64_tr_b16 v[138:139], v246 offset:4616
    ds_read_b64_tr_b16 v[140:141], v177 offset:0
    ds_read_b64_tr_b16 v[142:143], v177 offset:512
    ds_read_b64_tr_b16 v[144:145], v177 offset:4096
    ds_read_b64_tr_b16 v[146:147], v177 offset:4608
    ds_read_b64_tr_b16 v[148:149], v177 offset:8
    ds_read_b64_tr_b16 v[150:151], v177 offset:520
    ds_read_b64_tr_b16 v[152:153], v177 offset:4104
    ds_read_b64_tr_b16 v[154:155], v177 offset:4616
    v_pk_mul_f32 v[4:5], v[4:5], v[38:39] op_sel:[0,0] op_sel_hi:[1,0]
    v_pk_mul_f32 v[6:7], v[6:7], v[38:39] op_sel:[0,1] op_sel_hi:[1,1]
    v_pk_mul_f32 v[8:9], v[8:9], v[40:41] op_sel:[0,0] op_sel_hi:[1,0]
    v_pk_mul_f32 v[10:11], v[10:11], v[40:41] op_sel:[0,1] op_sel_hi:[1,1]
    v_pk_mul_f32 v[12:13], v[12:13], v[42:43] op_sel:[0,0] op_sel_hi:[1,0]
    v_pk_mul_f32 v[14:15], v[14:15], v[42:43] op_sel:[0,1] op_sel_hi:[1,1]
    v_pk_mul_f32 v[16:17], v[16:17], v[44:45] op_sel:[0,0] op_sel_hi:[1,0]
    v_pk_mul_f32 v[18:19], v[18:19], v[44:45] op_sel:[0,1] op_sel_hi:[1,1]
    s_mov_b64 exec, s[76:77]
    v_pk_fma_f32 v[20:21], v[20:21], v[106:107], v[20:21]
    v_pk_fma_f32 v[22:23], v[22:23], v[108:109], v[22:23]
    v_pk_fma_f32 v[24:25], v[24:25], v[110:111], v[24:25]
    v_pk_fma_f32 v[26:27], v[26:27], v[112:113], v[26:27]
    v_pk_fma_f32 v[28:29], v[28:29], v[114:115], v[28:29]
    v_pk_fma_f32 v[30:31], v[30:31], v[116:117], v[30:31]
    v_pk_fma_f32 v[32:33], v[32:33], v[118:119], v[32:33]
    v_pk_fma_f32 v[34:35], v[34:35], v[120:121], v[34:35]
    v_pk_fma_f32 v[20:21], v[54:55], v[88:89], v[20:21]
    v_pk_fma_f32 v[22:23], v[56:57], v[90:91], v[22:23]
    v_pk_fma_f32 v[24:25], v[58:59], v[92:93], v[24:25]
    v_pk_fma_f32 v[26:27], v[60:61], v[94:95], v[26:27]
    v_pk_fma_f32 v[28:29], v[62:63], v[96:97], v[28:29]
    v_pk_fma_f32 v[30:31], v[64:65], v[98:99], v[30:31]
    v_pk_fma_f32 v[32:33], v[66:67], v[100:101], v[32:33]
    v_pk_fma_f32 v[34:35], v[68:69], v[102:103], v[34:35]
    v_pk_fma_f32 v[88:89], v[88:89], v[106:107], v[88:89]
    v_pk_fma_f32 v[90:91], v[90:91], v[108:109], v[90:91]
    v_pk_fma_f32 v[92:93], v[92:93], v[110:111], v[92:93]
    v_pk_fma_f32 v[94:95], v[94:95], v[112:113], v[94:95]
    v_pk_fma_f32 v[96:97], v[96:97], v[114:115], v[96:97]
    v_pk_fma_f32 v[98:99], v[98:99], v[116:117], v[98:99]
    v_pk_fma_f32 v[100:101], v[100:101], v[118:119], v[100:101]
    v_pk_fma_f32 v[102:103], v[102:103], v[120:121], v[102:103]
    s_mov_b64 exec, -1
    v_mul_f32 v54, v88, v89
    v_mul_f32 v55, v90, v91
    v_mul_f32 v56, v92, v93
    v_mul_f32 v57, v94, v95
    v_mul_f32 v58, v96, v97
    v_mul_f32 v59, v98, v99
    v_mul_f32 v60, v100, v101
    v_mul_f32 v61, v102, v103
    v_pk_mul_f32 v[20:21], v[20:21], v[88:89] op_sel:[0,1] op_sel_hi:[1,0]
    v_pk_mul_f32 v[22:23], v[22:23], v[90:91] op_sel:[0,1] op_sel_hi:[1,0]
    v_pk_mul_f32 v[24:25], v[24:25], v[92:93] op_sel:[0,1] op_sel_hi:[1,0]
    v_pk_mul_f32 v[26:27], v[26:27], v[94:95] op_sel:[0,1] op_sel_hi:[1,0]
    v_pk_mul_f32 v[28:29], v[28:29], v[96:97] op_sel:[0,1] op_sel_hi:[1,0]
    v_pk_mul_f32 v[30:31], v[30:31], v[98:99] op_sel:[0,1] op_sel_hi:[1,0]
    v_pk_mul_f32 v[32:33], v[32:33], v[100:101] op_sel:[0,1] op_sel_hi:[1,0]
    v_pk_mul_f32 v[34:35], v[34:35], v[102:103] op_sel:[0,1] op_sel_hi:[1,0]
    v_pk_add_f32 v[88:89], v[54:55], v[56:57]
    v_pk_add_f32 v[90:91], v[58:59], v[60:61]
    v_pk_add_f32 v[88:89], v[88:89], v[90:91]
    v_add_f32 v250, v250, v88
    v_add_f32 v250, v250, v89
    v_rcp_f32 v54, v54
    v_rcp_f32 v55, v55
    v_rcp_f32 v56, v56
    v_rcp_f32 v57, v57
    v_rcp_f32 v58, v58
    v_rcp_f32 v59, v59
    v_rcp_f32 v60, v60
    v_rcp_f32 v61, v61
    v_cvt_pk_bf16_f32 v46, v4, v5
    v_cvt_pk_bf16_f32 v47, v6, v7
    v_cvt_pk_bf16_f32 v48, v8, v9
    v_cvt_pk_bf16_f32 v49, v10, v11
    ds_write_b128 v238, v[46:49]
    v_cvt_pk_bf16_f32 v50, v12, v13
    v_cvt_pk_bf16_f32 v51, v14, v15
    v_cvt_pk_bf16_f32 v52, v16, v17
    v_cvt_pk_bf16_f32 v53, v18, v19
    ds_write_b128 v239, v[50:53]
    v_pk_mul_f32 v[20:21], v[20:21], v[54:55] op_sel:[0,0] op_sel_hi:[1,0]
    v_pk_mul_f32 v[22:23], v[22:23], v[54:55] op_sel:[0,1] op_sel_hi:[1,1]
    v_pk_mul_f32 v[24:25], v[24:25], v[56:57] op_sel:[0,0] op_sel_hi:[1,0]
    v_pk_mul_f32 v[26:27], v[26:27], v[56:57] op_sel:[0,1] op_sel_hi:[1,1]
    v_pk_mul_f32 v[28:29], v[28:29], v[58:59] op_sel:[0,0] op_sel_hi:[1,0]
    v_pk_mul_f32 v[30:31], v[30:31], v[58:59] op_sel:[0,1] op_sel_hi:[1,1]
    v_pk_mul_f32 v[32:33], v[32:33], v[60:61] op_sel:[0,0] op_sel_hi:[1,0]
    v_pk_mul_f32 v[34:35], v[34:35], v[60:61] op_sel:[0,1] op_sel_hi:[1,1]
    v_cmp_ngt_f32 vcc, 0x6c800000, v250
    v_cvt_pk_bf16_f32 v62, v20, v21
    v_cvt_pk_bf16_f32 v63, v22, v23
    v_cvt_pk_bf16_f32 v64, v24, v25
    v_cvt_pk_bf16_f32 v65, v26, v27
    ds_write_b128 v240, v[62:65]
    v_cvt_pk_bf16_f32 v66, v28, v29
    v_cvt_pk_bf16_f32 v67, v30, v31
    v_cvt_pk_bf16_f32 v68, v32, v33
    v_cvt_pk_bf16_f32 v69, v34, v35
    ds_write_b128 v241, v[66:69]
    s_branch K_FLUSHED
.p2align 12
K_STB3:
    s_setpc_b64 s[0:1]
K_L15B:
    s_mov_b64 exec, -1
    s_waitcnt vmcnt(0) lgkmcnt(0)
    s_add_u32 m0, s86, 0
    ds_read_b128 v[156:159], v200 offset:32768
    ds_read_b128 v[160:163], v201 offset:32768
    ds_read_b64 v[186:187], v237 offset:24576
    buffer_load_dwordx4 v[188:189], s[28:31], 0 idxen offen offset:0 sc1 lds
    buffer_load_dwordx4 v[190:191], s[28:31], 0 idxen offen offset:1024 sc1 lds
    buffer_load_dwordx4 v[192:193], s[28:31], 0 idxen offen offset:2048 sc1 lds
    buffer_load_dwordx4 v[194:195], s[28:31], 0 idxen offen offset:3072 sc1 lds
    s_mov_b64 exec, s[72:73]
    s_setprio 1
    v_exp_f32 v106, v38
    v_exp_f32 v107, v39
    v_exp_f32 v108, v40
    v_mfma_f32_32x32x8_bf16 v[54:69], v[182:183], v[184:185], v[140:155]
    v_exp_f32 v109, v41
    v_exp_f32 v110, v42
    v_exp_f32 v111, v43
    v_exp_f32 v112, v44
    v_exp_f32 v113, v45
    v_smfmac_f32_32x32x32_bf16 v[54:69], v[172:175], v[164:171], v176
    v_exp_f32 v114, v46
    v_exp_f32 v115, v47
    v_exp_f32 v116, v48
    v_exp_f32 v117, v49
    v_exp_f32 v118, v50
    v_exp_f32 v119, v51
    v_exp_f32 v120, v52
    v_exp_f32 v121, v53
    s_setprio 3
    v_fmac_f32 v4, v4, v106
    v_fmac_f32 v5, v5, v107
    v_fmac_f32 v6, v6, v108
    v_fmac_f32 v7, v7, v109
    v_fmac_f32 v8, v8, v110
    v_fmac_f32 v9, v9, v111
    v_fmac_f32 v10, v10, v112
    v_fmac_f32 v11, v11, v113
    v_fmac_f32 v12, v12, v114
    v_fmac_f32 v13, v13, v115
    v_fmac_f32 v14, v14, v116
    v_fmac_f32 v15, v15, v117
    v_fmac_f32 v16, v16, v118
    v_fmac_f32 v17, v17, v119
    v_fmac_f32 v18, v18, v120
    v_fmac_f32 v19, v19, v121
    v_fmac_f32 v4, v38, v72
    v_fmac_f32 v5, v39, v73
    v_fmac_f32 v6, v40, v74
    v_fmac_f32 v7, v41, v75
    v_fmac_f32 v8, v42, v76
    v_fmac_f32 v9, v43, v77
    v_fmac_f32 v10, v44, v78
    v_fmac_f32 v11, v45, v79
    v_fmac_f32 v12, v46, v80
    v_fmac_f32 v13, v47, v81
    v_fmac_f32 v14, v48, v82
    v_fmac_f32 v15, v49, v83
    v_fmac_f32 v16, v50, v84
    v_fmac_f32 v17, v51, v85
    v_fmac_f32 v18, v52, v86
    v_fmac_f32 v19, v53, v87
    v_fmac_f32 v72, v72, v106
    v_fmac_f32 v73, v73, v107
    v_fmac_f32 v74, v74, v108
    v_fmac_f32 v75, v75, v109
    v_fmac_f32 v76, v76, v110
    v_fmac_f32 v77, v77, v111
    v_fmac_f32 v78, v78, v112
    v_fmac_f32 v79, v79, v113
    v_fmac_f32 v80, v80, v114
    v_fmac_f32 v81, v81, v115
    v_fmac_f32 v82, v82, v116
    v_fmac_f32 v83, v83, v117
    v_fmac_f32 v84, v84, v118
    v_fmac_f32 v85, v85, v119
    v_fmac_f32 v86, v86, v120
    v_fmac_f32 v87, v87, v121
    s_mov_b64 exec, -1
    s_waitcnt lgkmcnt(0)
    ds_read_b128 v[164:167], v202 offset:32768
    ds_read_b128 v[168:171], v203 offset:32768
    ds_read_u16 v237, v236 offset:58
    s_mov_b64 exec, s[72:73]
    s_setprio 1
    v_exp_f32 v106, v54
    v_exp_f32 v107, v55
    v_exp_f32 v108, v56
    v_mfma_f32_32x32x8_bf16 v[38:53], v[180:181], v[186:187], v[124:139]
    v_exp_f32 v109, v57
    v_exp_f32 v110, v58
    v_exp_f32 v111, v59
    v_exp_f32 v112, v60
    v_exp_f32 v113, v61
    v_smfmac_f32_32x32x32_bf16 v[38:53], v[172:175], v[156:163], v176
    v_exp_f32 v114, v62
    v_exp_f32 v115, v63
    v_exp_f32 v116, v64
    v_exp_f32 v117, v65
    v_exp_f32 v118, v66
    v_exp_f32 v119, v67
    v_exp_f32 v120, v68
    v_exp_f32 v121, v69
    s_setprio 3
    v_fmac_f32 v20, v20, v106
    v_fmac_f32 v21, v21, v107
    v_fmac_f32 v22, v22, v108
    v_fmac_f32 v23, v23, v109
    v_fmac_f32 v24, v24, v110
    v_fmac_f32 v25, v25, v111
    v_fmac_f32 v26, v26, v112
    v_fmac_f32 v27, v27, v113
    v_fmac_f32 v28, v28, v114
    v_fmac_f32 v29, v29, v115
    v_fmac_f32 v30, v30, v116
    v_fmac_f32 v31, v31, v117
    v_fmac_f32 v32, v32, v118
    v_fmac_f32 v33, v33, v119
    v_fmac_f32 v34, v34, v120
    v_fmac_f32 v35, v35, v121
    v_fmac_f32 v20, v54, v88
    v_fmac_f32 v21, v55, v89
    v_fmac_f32 v22, v56, v90
    v_fmac_f32 v23, v57, v91
    v_fmac_f32 v24, v58, v92
    v_fmac_f32 v25, v59, v93
    v_fmac_f32 v26, v60, v94
    v_fmac_f32 v27, v61, v95
    v_fmac_f32 v28, v62, v96
    v_fmac_f32 v29, v63, v97
    v_fmac_f32 v30, v64, v98
    v_fmac_f32 v31, v65, v99
    v_fmac_f32 v32, v66, v100
    v_fmac_f32 v33, v67, v101
    v_fmac_f32 v34, v68, v102
    v_fmac_f32 v35, v69, v103
    v_fmac_f32 v88, v88, v106
    v_fmac_f32 v89, v89, v107
    v_fmac_f32 v90, v90, v108
    v_fmac_f32 v91, v91, v109
    v_fmac_f32 v92, v92, v110
    v_fmac_f32 v93, v93, v111
    v_fmac_f32 v94, v94, v112
    v_fmac_f32 v95, v95, v113
    v_fmac_f32 v96, v96, v114
    v_fmac_f32 v97, v97, v115
    v_fmac_f32 v98, v98, v116
    v_fmac_f32 v99, v99, v117
    v_fmac_f32 v100, v100, v118
    v_fmac_f32 v101, v101, v119
    v_fmac_f32 v102, v102, v120
    v_fmac_f32 v103, v103, v121
    s_mov_b64 exec, -1
    s_waitcnt vmcnt(0) lgkmcnt(0)
    ds_read_b128 v[156:159], v200 offset:0
    ds_read_b128 v[160:163], v201 offset:0
    ds_read_b64 v[184:185], v237 offset:24576
    s_mov_b64 exec, s[74:75]
    s_setprio 1
    v_exp_f32 v106, v38
    v_exp_f32 v107, v39
    v_exp_f32 v108, v40
    v_mfma_f32_32x32x8_bf16 v[54:69], v[182:183], v[186:187], v[140:155]
    v_exp_f32 v109, v41
    v_exp_f32 v110, v42
    v_exp_f32 v111, v43
    v_exp_f32 v112, v44
    v_exp_f32 v113, v45
    v_smfmac_f32_32x32x32_bf16 v[54:69], v[172:175], v[164:171], v176
    v_exp_f32 v114, v46
    v_exp_f32 v115, v47
    v_exp_f32 v116, v48
    v_exp_f32 v117, v49
    v_exp_f32 v118, v50
    v_exp_f32 v119, v51
    v_exp_f32 v120, v52
    v_exp_f32 v121, v53
    s_setprio 3
    v_fmac_f32 v4, v4, v106
    v_fmac_f32 v5, v5, v107
    v_fmac_f32 v6, v6, v108
    v_fmac_f32 v7, v7, v109
    v_fmac_f32 v8, v8, v110
    v_fmac_f32 v9, v9, v111
    v_fmac_f32 v10, v10, v112
    v_fmac_f32 v11, v11, v113
    v_fmac_f32 v12, v12, v114
    v_fmac_f32 v13, v13, v115
    v_fmac_f32 v14, v14, v116
    v_fmac_f32 v15, v15, v117
    v_fmac_f32 v16, v16, v118
    v_fmac_f32 v17, v17, v119
    v_fmac_f32 v18, v18, v120
    v_fmac_f32 v19, v19, v121
    v_fmac_f32 v4, v38, v72
    v_fmac_f32 v5, v39, v73
    v_fmac_f32 v6, v40, v74
    v_fmac_f32 v7, v41, v75
    v_fmac_f32 v8, v42, v76
    v_fmac_f32 v9, v43, v77
    v_fmac_f32 v10, v44, v78
    v_fmac_f32 v11, v45, v79
    v_fmac_f32 v12, v46, v80
    v_fmac_f32 v13, v47, v81
    v_fmac_f32 v14, v48, v82
    v_fmac_f32 v15, v49, v83
    v_fmac_f32 v16, v50, v84
    v_fmac_f32 v17, v51, v85
    v_fmac_f32 v18, v52, v86
    v_fmac_f32 v19, v53, v87
    v_fmac_f32 v72, v72, v106
    v_fmac_f32 v73, v73, v107
    v_fmac_f32 v74, v74, v108
    v_fmac_f32 v75, v75, v109
    v_fmac_f32 v76, v76, v110
    v_fmac_f32 v77, v77, v111
    v_fmac_f32 v78, v78, v112
    v_fmac_f32 v79, v79, v113
    v_fmac_f32 v80, v80, v114
    v_fmac_f32 v81, v81, v115
    v_fmac_f32 v82, v82, v116
    v_fmac_f32 v83, v83, v117
    v_fmac_f32 v84, v84, v118
    v_fmac_f32 v85, v85, v119
    v_fmac_f32 v86, v86, v120
    v_fmac_f32 v87, v87, v121
    s_mov_b64 exec, -1
    s_waitcnt lgkmcnt(0)
    ds_read_b128 v[164:167], v202 offset:0
    ds_read_b128 v[168:171], v203 offset:0
    s_mov_b64 exec, s[74:75]
    s_setprio 1
    v_exp_f32 v106, v54
    v_exp_f32 v107, v55
    v_exp_f32 v108, v56
    v_mfma_f32_32x32x8_bf16 v[38:53], v[180:181], v[184:185], v[124:139]
    v_exp_f32 v109, v57
    v_exp_f32 v110, v58
    v_exp_f32 v111, v59
    v_exp_f32 v112, v60
    v_exp_f32 v113, v61
    v_smfmac_f32_32x32x32_bf16 v[38:53], v[172:175], v[156:163], v176
    v_exp_f32 v114, v62
    v_exp_f32 v115, v63
    v_exp_f32 v116, v64
    v_exp_f32 v117, v65
    v_exp_f32 v118, v66
    v_exp_f32 v119, v67
    v_exp_f32 v120, v68
    v_exp_f32 v121, v69
    s_setprio 3
    v_fmac_f32 v20, v20, v106
    v_fmac_f32 v21, v21, v107
    v_fmac_f32 v22, v22, v108
    v_fmac_f32 v23, v23, v109
    v_fmac_f32 v24, v24, v110
    v_fmac_f32 v25, v25, v111
    v_fmac_f32 v26, v26, v112
    v_fmac_f32 v27, v27, v113
    v_fmac_f32 v28, v28, v114
    v_fmac_f32 v29, v29, v115
    v_fmac_f32 v30, v30, v116
    v_fmac_f32 v31, v31, v117
    v_fmac_f32 v32, v32, v118
    v_fmac_f32 v33, v33, v119
    v_fmac_f32 v34, v34, v120
    v_fmac_f32 v35, v35, v121
    v_fmac_f32 v20, v54, v88
    v_fmac_f32 v21, v55, v89
    v_fmac_f32 v22, v56, v90
    v_fmac_f32 v23, v57, v91
    v_fmac_f32 v24, v58, v92
    v_fmac_f32 v25, v59, v93
    v_fmac_f32 v26, v60, v94
    v_fmac_f32 v27, v61, v95
    v_fmac_f32 v28, v62, v96
    v_fmac_f32 v29, v63, v97
    v_fmac_f32 v30, v64, v98
    v_fmac_f32 v31, v65, v99
    v_fmac_f32 v32, v66, v100
    v_fmac_f32 v33, v67, v101
    v_fmac_f32 v34, v68, v102
    v_fmac_f32 v35, v69, v103
    v_fmac_f32 v88, v88, v106
    v_fmac_f32 v89, v89, v107
    v_fmac_f32 v90, v90, v108
    v_fmac_f32 v91, v91, v109
    v_fmac_f32 v92, v92, v110
    v_fmac_f32 v93, v93, v111
    v_fmac_f32 v94, v94, v112
    v_fmac_f32 v95, v95, v113
    v_fmac_f32 v96, v96, v114
    v_fmac_f32 v97, v97, v115
    v_fmac_f32 v98, v98, v116
    v_fmac_f32 v99, v99, v117
    v_fmac_f32 v100, v100, v118
    v_fmac_f32 v101, v101, v119
    v_fmac_f32 v102, v102, v120
    v_fmac_f32 v103, v103, v121
    s_mov_b64 exec, -1
    s_waitcnt vmcnt(0) lgkmcnt(0)
    s_mov_b64 exec, s[76:77]
    s_setprio 1
    v_exp_f32 v106, v38
    v_exp_f32 v107, v39
    v_exp_f32 v108, v40
    v_mfma_f32_32x32x8_bf16 v[54:69], v[182:183], v[184:185], v[140:155]
    v_exp_f32 v109, v41
    v_exp_f32 v110, v42
    v_exp_f32 v111, v43
    v_exp_f32 v112, v44
    v_exp_f32 v113, v45
    v_smfmac_f32_32x32x32_bf16 v[54:69], v[172:175], v[164:171], v176
    v_exp_f32 v114, v46
    v_exp_f32 v115, v47
    v_exp_f32 v116, v48
    v_exp_f32 v117, v49
    v_exp_f32 v118, v50
    v_exp_f32 v119, v51
    v_exp_f32 v120, v52
    v_exp_f32 v121, v53
    s_setprio 3
    v_fmac_f32 v4, v4, v106
    v_fmac_f32 v5, v5, v107
    v_fmac_f32 v6, v6, v108
    v_fmac_f32 v7, v7, v109
    v_fmac_f32 v8, v8, v110
    v_fmac_f32 v9, v9, v111
    v_fmac_f32 v10, v10, v112
    v_fmac_f32 v11, v11, v113
    v_fmac_f32 v12, v12, v114
    v_fmac_f32 v13, v13, v115
    v_fmac_f32 v14, v14, v116
    v_fmac_f32 v15, v15, v117
    v_fmac_f32 v16, v16, v118
    v_fmac_f32 v17, v17, v119
    v_fmac_f32 v18, v18, v120
    v_fmac_f32 v19, v19, v121
    v_fmac_f32 v4, v38, v72
    v_fmac_f32 v5, v39, v73
    v_fmac_f32 v6, v40, v74
    v_fmac_f32 v7, v41, v75
    v_fmac_f32 v8, v42, v76
    v_fmac_f32 v9, v43, v77
    v_fmac_f32 v10, v44, v78
    v_fmac_f32 v11, v45, v79
    v_fmac_f32 v12, v46, v80
    v_fmac_f32 v13, v47, v81
    v_fmac_f32 v14, v48, v82
    v_fmac_f32 v15, v49, v83
    v_fmac_f32 v16, v50, v84
    v_fmac_f32 v17, v51, v85
    v_fmac_f32 v18, v52, v86
    v_fmac_f32 v19, v53, v87
    v_fmac_f32 v72, v72, v106
    v_fmac_f32 v73, v73, v107
    v_fmac_f32 v74, v74, v108
    v_fmac_f32 v75, v75, v109
    v_fmac_f32 v76, v76, v110
    v_fmac_f32 v77, v77, v111
    v_fmac_f32 v78, v78, v112
    v_fmac_f32 v79, v79, v113
    v_fmac_f32 v80, v80, v114
    v_fmac_f32 v81, v81, v115
    v_fmac_f32 v82, v82, v116
    v_fmac_f32 v83, v83, v117
    v_fmac_f32 v84, v84, v118
    v_fmac_f32 v85, v85, v119
    v_fmac_f32 v86, v86, v120
    v_fmac_f32 v87, v87, v121
    s_mov_b64 exec, -1
    v_mul_f32 v38, v72, v73
    v_mul_f32 v39, v74, v75
    v_mul_f32 v40, v76, v77
    v_mul_f32 v41, v78, v79
    v_mul_f32 v42, v80, v81
    v_mul_f32 v43, v82, v83
    v_mul_f32 v44, v84, v85
    v_mul_f32 v45, v86, v87
    v_mul_f32 v4, v4, v73
    v_mul_f32 v5, v5, v72
    v_mul_f32 v6, v6, v75
    v_mul_f32 v7, v7, v74
    v_mul_f32 v8, v8, v77
    v_mul_f32 v9, v9, v76
    v_mul_f32 v10, v10, v79
    v_mul_f32 v11, v11, v78
    v_mul_f32 v12, v12, v81
    v_mul_f32 v13, v13, v80
    v_mul_f32 v14, v14, v83
    v_mul_f32 v15, v15, v82
    v_mul_f32 v16, v16, v85
    v_mul_f32 v17, v17, v84
    v_mul_f32 v18, v18, v87
    v_mul_f32 v19, v19, v86
    v_add_f32 v250, v250, v38
    v_add_f32 v250, v250, v39
    v_add_f32 v250, v250, v40
    v_add_f32 v250, v250, v41
    v_add_f32 v250, v250, v42
    v_add_f32 v250, v250, v43
    v_add_f32 v250, v250, v44
    v_add_f32 v250, v250, v45
    s_mov_b64 exec, -1
    s_setprio 1
    v_rcp_f32 v38, v38
    v_rcp_f32 v39, v39
    v_rcp_f32 v40, v40
    v_rcp_f32 v41, v41
    v_rcp_f32 v42, v42
    v_rcp_f32 v43, v43
    v_rcp_f32 v44, v44
    v_rcp_f32 v45, v45
    v_exp_f32 v106, v54
    v_exp_f32 v107, v55
    v_exp_f32 v108, v56
    v_exp_f32 v109, v57
    v_exp_f32 v110, v58
    v_exp_f32 v111, v59
    v_exp_f32 v112, v60
    v_exp_f32 v113, v61
    v_exp_f32 v114, v62
    v_exp_f32 v115, v63
    v_exp_f32 v116, v64
    v_exp_f32 v117, v65
    v_exp_f32 v118, v66
    v_exp_f32 v119, v67
    v_exp_f32 v120, v68
    v_exp_f32 v121, v69
    v_pk_mul_f32 v[4:5], v[4:5], v[38:39] op_sel:[0,0] op_sel_hi:[1,0]
    v_pk_mul_f32 v[6:7], v[6:7], v[38:39] op_sel:[0,1] op_sel_hi:[1,1]
    v_pk_mul_f32 v[8:9], v[8:9], v[40:41] op_sel:[0,0] op_sel_hi:[1,0]
    v_pk_mul_f32 v[10:11], v[10:11], v[40:41] op_sel:[0,1] op_sel_hi:[1,1]
    v_pk_mul_f32 v[12:13], v[12:13], v[42:43] op_sel:[0,0] op_sel_hi:[1,0]
    v_pk_mul_f32 v[14:15], v[14:15], v[42:43] op_sel:[0,1] op_sel_hi:[1,1]
    v_pk_mul_f32 v[16:17], v[16:17], v[44:45] op_sel:[0,0] op_sel_hi:[1,0]
    v_pk_mul_f32 v[18:19], v[18:19], v[44:45] op_sel:[0,1] op_sel_hi:[1,1]
    s_mov_b64 exec, s[76:77]
    v_pk_fma_f32 v[20:21], v[20:21], v[106:107], v[20:21]
    v_pk_fma_f32 v[22:23], v[22:23], v[108:109], v[22:23]
    v_pk_fma_f32 v[24:25], v[24:25], v[110:111], v[24:25]
    v_pk_fma_f32 v[26:27], v[26:27], v[112:113], v[26:27]
    v_pk_fma_f32 v[28:29], v[28:29], v[114:115], v[28:29]
    v_pk_fma_f32 v[30:31], v[30:31], v[116:117], v[30:31]
    v_pk_fma_f32 v[32:33], v[32:33], v[118:119], v[32:33]
    v_pk_fma_f32 v[34:35], v[34:35], v[120:121], v[34:35]
    v_pk_fma_f32 v[20:21], v[54:55], v[88:89], v[20:21]
    v_pk_fma_f32 v[22:23], v[56:57], v[90:91], v[22:23]
    v_pk_fma_f32 v[24:25], v[58:59], v[92:93], v[24:25]
    v_pk_fma_f32 v[26:27], v[60:61], v[94:95], v[26:27]
    v_pk_fma_f32 v[28:29], v[62:63], v[96:97], v[28:29]
    v_pk_fma_f32 v[30:31], v[64:65], v[98:99], v[30:31]
    v_pk_fma_f32 v[32:33], v[66:67], v[100:101], v[32:33]
    v_pk_fma_f32 v[34:35], v[68:69], v[102:103], v[34:35]
    v_pk_fma_f32 v[88:89], v[88:89], v[106:107], v[88:89]
    v_pk_fma_f32 v[90:91], v[90:91], v[108:109], v[90:91]
    v_pk_fma_f32 v[92:93], v[92:93], v[110:111], v[92:93]
    v_pk_fma_f32 v[94:95], v[94:95], v[112:113], v[94:95]
    v_pk_fma_f32 v[96:97], v[96:97], v[114:115], v[96:97]
    v_pk_fma_f32 v[98:99], v[98:99], v[116:117], v[98:99]
    v_pk_fma_f32 v[100:101], v[100:101], v[118:119], v[100:101]
    v_pk_fma_f32 v[102:103], v[102:103], v[120:121], v[102:103]
    s_mov_b64 exec, -1
    v_mul_f32 v54, v88, v89
    v_mul_f32 v55, v90, v91
    v_mul_f32 v56, v92, v93
    v_mul_f32 v57, v94, v95
    v_mul_f32 v58, v96, v97
    v_mul_f32 v59, v98, v99
    v_mul_f32 v60, v100, v101
    v_mul_f32 v61, v102, v103
    v_pk_mul_f32 v[20:21], v[20:21], v[88:89] op_sel:[0,1] op_sel_hi:[1,0]
    v_pk_mul_f32 v[22:23], v[22:23], v[90:91] op_sel:[0,1] op_sel_hi:[1,0]
    v_pk_mul_f32 v[24:25], v[24:25], v[92:93] op_sel:[0,1] op_sel_hi:[1,0]
    v_pk_mul_f32 v[26:27], v[26:27], v[94:95] op_sel:[0,1] op_sel_hi:[1,0]
    v_pk_mul_f32 v[28:29], v[28:29], v[96:97] op_sel:[0,1] op_sel_hi:[1,0]
    v_pk_mul_f32 v[30:31], v[30:31], v[98:99] op_sel:[0,1] op_sel_hi:[1,0]
    v_pk_mul_f32 v[32:33], v[32:33], v[100:101] op_sel:[0,1] op_sel_hi:[1,0]
    v_pk_mul_f32 v[34:35], v[34:35], v[102:103] op_sel:[0,1] op_sel_hi:[1,0]
    v_pk_add_f32 v[88:89], v[54:55], v[56:57]
    v_pk_add_f32 v[90:91], v[58:59], v[60:61]
    v_pk_add_f32 v[88:89], v[88:89], v[90:91]
    v_add_f32 v250, v250, v88
    v_add_f32 v250, v250, v89
    v_rcp_f32 v54, v54
    v_rcp_f32 v55, v55
    v_rcp_f32 v56, v56
    v_rcp_f32 v57, v57
    v_rcp_f32 v58, v58
    v_rcp_f32 v59, v59
    v_rcp_f32 v60, v60
    v_rcp_f32 v61, v61
    v_cvt_pk_bf16_f32 v46, v4, v5
    v_cvt_pk_bf16_f32 v47, v6, v7
    v_cvt_pk_bf16_f32 v48, v8, v9
    v_cvt_pk_bf16_f32 v49, v10, v11
    ds_write_b128 v238, v[46:49]
    v_cvt_pk_bf16_f32 v50, v12, v13
    v_cvt_pk_bf16_f32 v51, v14, v15
    v_cvt_pk_bf16_f32 v52, v16, v17
    v_cvt_pk_bf16_f32 v53, v18, v19
    ds_write_b128 v239, v[50:53]
    v_pk_mul_f32 v[20:21], v[20:21], v[54:55] op_sel:[0,0] op_sel_hi:[1,0]
    v_pk_mul_f32 v[22:23], v[22:23], v[54:55] op_sel:[0,1] op_sel_hi:[1,1]
    v_pk_mul_f32 v[24:25], v[24:25], v[56:57] op_sel:[0,0] op_sel_hi:[1,0]
    v_pk_mul_f32 v[26:27], v[26:27], v[56:57] op_sel:[0,1] op_sel_hi:[1,1]
    v_pk_mul_f32 v[28:29], v[28:29], v[58:59] op_sel:[0,0] op_sel_hi:[1,0]
    v_pk_mul_f32 v[30:31], v[30:31], v[58:59] op_sel:[0,1] op_sel_hi:[1,1]
    v_pk_mul_f32 v[32:33], v[32:33], v[60:61] op_sel:[0,0] op_sel_hi:[1,0]
    v_pk_mul_f32 v[34:35], v[34:35], v[60:61] op_sel:[0,1] op_sel_hi:[1,1]
    v_cmp_ngt_f32 vcc, 0x6c800000, v250
    v_cvt_pk_bf16_f32 v62, v20, v21
    v_cvt_pk_bf16_f32 v63, v22, v23
    v_cvt_pk_bf16_f32 v64, v24, v25
    v_cvt_pk_bf16_f32 v65, v26, v27
    ds_write_b128 v240, v[62:65]
    v_cvt_pk_bf16_f32 v66, v28, v29
    v_cvt_pk_bf16_f32 v67, v30, v31
    v_cvt_pk_bf16_f32 v68, v32, v33
    v_cvt_pk_bf16_f32 v69, v34, v35
    ds_write_b128 v241, v[66:69]
    s_branch K_FLUSHED
K_MORE:
    v_mov_b32 v252, 0
    s_cmp_lg_u32 s85, 0
    s_cbranch_scc1 K_INL
    ds_write_b32 v252, v252 offset:24568
    s_branch K_NOMORE
K_INL:
    s_ff1_i32_b64 s92, vcc
    s_bcnt1_i32_b64 s93, vcc
    s_mov_b64 exec, 1
    ds_wrxchg_rtn_b32 v253, v252, v252 offset:24564
    s_mov_b64 exec, -1
    v_readlane_b32 s95, v249, s92
    v_readlane_b32 s12, v60, s92
    v_readlane_b32 s92, v8, s92
    s_sub_u32 s95, s95, 128
    s_lshr_b32 s12, s12, 11
    s_mul_i32 s12, s12, 12800
    s_add_u32 s12, s12, s92
    s_add_u32 s12, s12, 128
    s_waitcnt lgkmcnt(0)
    v_readfirstlane_b32 s92, v253
    v_lshlrev_b32 v253, 2, v1
    s_cmp_lg_u32 s93, 2
    s_cbranch_scc1 K_INF
    s_cmp_gt_u32 s95, 64
    s_cbranch_scc1 K_INF
    s_cmp_eq_u32 s92, 0
    s_cbranch_scc1 K_INF
    v_lshlrev_b32 v254, 19, v1
    v_add_u32 v254, 0xff800000, v254
    v_mov_b32 v252, 4
    v_cmpx_gt_u32 vcc, s95, v253
    buffer_load_dword v255, v253, s[20:23], s12 offen sc1
    s_waitcnt vmcnt(0)
    v_lshrrev_b32 v253, 24, v255
    v_and_b32 v253, 0xfc, v253
    ds_add_rtn_u32 v253, v253, v252 offset:0
    v_and_b32 v255, 0x3fff, v255
    v_or_b32 v255, v255, v254
    s_waitcnt lgkmcnt(0)
    ds_write_b32 v253, v255
    s_mov_b64 exec, -1
    s_branch K_NOMORE
K_INF:
    s_mov_b32 s95, 0
    s_mov_b32 exec_lo, 0
    s_mov_b32 exec_hi, 0x80000000
    ds_write_b32 v233, v252 offset:0
    s_mov_b64 exec, -1
    s_branch K_NOMORE
K_XE:
    v_lshlrev_b32 v254, 3, v1
    v_lshlrev_b32 v255, 4, v1
    s_lshl_b32 s12, s12, 1
    s_add_u32 s12, s12, 4096
    s_mov_b32 m0, 89984
    v_cmpx_gt_u32 vcc, s95, v254
    buffer_load_dwordx4 v255, s[24:27], s12 offen sc1 lds
    s_mov_b64 exec, -1
    s_branch K_XED
K_FLAG:
    v_mov_b32 v252, 0
    ds_write_b32 v252, v252 offset:24572
    s_branch K_JOIN
K_RETRY:
    s_cmp_lg_u32 s85, 0
    s_mov_b32 s85, 0
    s_cbranch_scc1 K_AGAIN
    s_lshr_b32 s83, s83, 1
    s_cbranch_scc0 K_END
    s_branch K_AGAIN
K_TOSAFE:
    s_mov_b32 s84, 1
K_AGAIN:
    s_waitcnt vmcnt(0) lgkmcnt(0)
    s_barrier
    v_and_b32 v100, 56, v0
    v_lshlrev_b32 v100, 1, v100
    v_xor_b32 v100, v100, v2
    v_and_b32 v101, 16, v0
    v_lshlrev_b32 v101, 2, v101
    v_xor_b32 v101, v101, v2
    v_lshrrev_b32 v102, 3, v247
    v_and_b32 v102, 0x70, v102
    v_xor_b32 v102, v102, v247
    v_add_u32 v102, 110592, v102
    v_xor_b32 v103, 64, v102
    s_add_u32 m0, s101, 90112
    s_nop 0
    buffer_load_dwordx4 v101, s[40:43], s100 offen lds
    s_add_u32 m0, s101, 110592
    s_nop 0
    buffer_load_dwordx4 v100, s[36:39], 0 offen lds
    v_subrev_u32 v251, 80, v0
    v_mul_u32_u24 v254, 57, v251
    v_lshrrev_b32 v254, 9, v254
    v_mad_i32_i24 v255, v254, -10, v251
    v_max_i32 v255, 0, v255
    v_bfm_b32 v255, v255, v254
    v_mov_b32 v40, 0xfb803fff
    v_mov_b32 v41, 0xfb803fff
    v_mov_b32 v42, 0xfb803fff
    v_mov_b32 v43, 0xfb803fff
    ds_write_b128 v2, v[40:43] offset:8192
    ds_write_b128 v2, v[40:43] offset:16384
    s_cmp_ge_u32 s80, 3
    s_cbranch_scc1 1f
    s_mov_b32 s92, 0x3f800000
    v_cmpx_gt_u32 vcc, 161, v0
    v_bfe_i32 v40, v255, 0, 1
    v_bfe_i32 v254, v255, 1, 1
    v_and_b32 v40, 0x3f80, v40
    v_and_or_b32 v40, v254, s92, v40
    v_bfe_i32 v41, v255, 2, 1
    v_bfe_i32 v254, v255, 3, 1
    v_and_b32 v41, 0x3f80, v41
    v_and_or_b32 v41, v254, s92, v41
    v_bfe_i32 v42, v255, 4, 1
    v_bfe_i32 v254, v255, 5, 1
    v_and_b32 v42, 0x3f80, v42
    v_and_or_b32 v42, v254, s92, v42
    v_bfe_i32 v43, v255, 6, 1
    v_bfe_i32 v254, v255, 7, 1
    v_and_b32 v43, 0x3f80, v43
    v_and_or_b32 v43, v254, s92, v43
    v_cmpx_gt_u32 vcc, 80, v0
    v_mov_b32 v40, 2576
    v_mov_b32 v41, 2576
    v_mov_b32 v42, 2576
    v_mov_b32 v43, 2576
    s_mov_b64 exec, -1
1:
    ds_write_b128 v2, v[40:43]
    s_cmp_lg_u32 s80, 0
    s_cbranch_scc1 2f
    ds_write_b32 v233, v232 offset:0
    v_mov_b32 v254, 88960
    v_mov_b32 v40, 0
    v_mov_b32 v41, 0
    ds_write_b64 v254, v[40:41]
2:
    s_waitcnt vmcnt(0) lgkmcnt(0)
    s_barrier
    s_cmp_lt_u32 s80, 4
    s_cbranch_scc1 K_ROUND
    ds_read_b128 v[108:111], v102
    ds_read_b128 v[112:115], v103
    v_add_u32 v252, 0xffff0000, v246
    v_add_u32 v253, 0xffff0000, v177
    ds_read_b64_tr_b16 v[124:125], v252 offset:0
    ds_read_b64_tr_b16 v[126:127], v252 offset:512
    ds_read_b64_tr_b16 v[128:129], v252 offset:4096
    ds_read_b64_tr_b16 v[130:131], v252 offset:4608
    ds_read_b64_tr_b16 v[132:133], v252 offset:8
    ds_read_b64_tr_b16 v[134:135], v252 offset:520
    ds_read_b64_tr_b16 v[136:137], v252 offset:4104
    ds_read_b64_tr_b16 v[138:139], v252 offset:4616
    ds_read_b64_tr_b16 v[140:141], v253 offset:0
    ds_read_b64_tr_b16 v[142:143], v253 offset:512
    ds_read_b64_tr_b16 v[144:145], v253 offset:4096
    ds_read_b64_tr_b16 v[146:147], v253 offset:4608
    ds_read_b64_tr_b16 v[148:149], v253 offset:8
    ds_read_b64_tr_b16 v[150:151], v253 offset:520
    ds_read_b64_tr_b16 v[152:153], v253 offset:4104
    ds_read_b64_tr_b16 v[154:155], v253 offset:4616
    s_waitcnt lgkmcnt(0)
    v_mfma_f32_16x16x32_bf16 v[156:159], v[124:127], v[108:111], 0
    v_mfma_f32_16x16x32_bf16 v[160:163], v[132:135], v[108:111], 0
    v_mfma_f32_16x16x32_bf16 v[164:167], v[140:143], v[108:111], 0
    v_mfma_f32_16x16x32_bf16 v[168:171], v[148:151], v[108:111], 0
    v_mfma_f32_16x16x32_bf16 v[156:159], v[128:131], v[112:115], v[156:159]
    v_mfma_f32_16x16x32_bf16 v[160:163], v[136:139], v[112:115], v[160:163]
    v_mfma_f32_16x16x32_bf16 v[164:167], v[144:147], v[112:115], v[164:167]
    v_mfma_f32_16x16x32_bf16 v[168:171], v[152:155], v[112:115], v[168:171]
    s_nop 7
    v_mul_f32 v156, 0xbfb8aa3b, v156
    v_mul_f32 v157, 0xbfb8aa3b, v157
    v_mul_f32 v158, 0xbfb8aa3b, v158
    v_mul_f32 v159, 0xbfb8aa3b, v159
    v_mul_f32 v160, 0xbfb8aa3b, v160
    v_mul_f32 v161, 0xbfb8aa3b, v161
    v_mul_f32 v162, 0xbfb8aa3b, v162
    v_mul_f32 v163, 0xbfb8aa3b, v163
    v_mul_f32 v164, 0xbfb8aa3b, v164
    v_mul_f32 v165, 0xbfb8aa3b, v165
    v_mul_f32 v166, 0xbfb8aa3b, v166
    v_mul_f32 v167, 0xbfb8aa3b, v167
    v_mul_f32 v168, 0xbfb8aa3b, v168
    v_mul_f32 v169, 0xbfb8aa3b, v169
    v_mul_f32 v170, 0xbfb8aa3b, v170
    v_mul_f32 v171, 0xbfb8aa3b, v171
    v_lshrrev_b32 v252, 7, v247
    v_mul_u32_u24 v252, 272, v252
    v_and_b32 v253, 48, v1
    v_lshl_add_u32 v252, v253, 1, v252
    v_add_u32 v252, 122880, v252
    ds_write_b128 v252, v[156:159] offset:0
    ds_write_b128 v252, v[160:163] offset:16
    ds_write_b128 v252, v[164:167] offset:128
    ds_write_b128 v252, v[168:171] offset:144
K_ROUND:
    v_and_b32 v253, 7, v0
    v_lshlrev_b32 v56, 4, v253
    v_sub_u32 v58, 0, v56
    v_ashrrev_i32 v59, 1, v58
    v_lshrrev_b32 v252, 3, v0
    v_mul_u32_u24 v57, 51200, v252
    v_add3_u32 v57, v57, s81, v56
    v_and_b32 v254, 3, v0
    v_lshl_add_u32 v252, v252, 2, v254
    v_lshlrev_b32 v60, 11, v252
    v_lshlrev_b32 v61, 10, v252
    v_subrev_u32 v252, s82, v252
    v_cmp_gt_u32 s[50:51], s83, v252
    s_mov_b32 s52, 12800
    s_mov_b32 s53, 25600
    s_mov_b32 s54, 38400
    v_and_b32 v254, 3, v0
    v_lshlrev_b32 v252, 5, v254
    v_and_b32 v253, 4, v0
    v_lshl_add_u32 v252, v253, 8, v252
    v_and_b32 v253, 56, v0
    v_lshl_add_u32 v252, v253, 4, v252
    s_lshl_b32 s92, s80, 29
    v_lshl_add_u32 v220, v252, 16, s92
    v_add_u32 v221, 0x80000, v220
    v_add_u32 v222, 0x100000, v220
    v_add_u32 v223, 0x180000, v220
    v_add_u32 v224, 0x8000000, v220
    v_add_u32 v225, 0x8080000, v220
    v_add_u32 v226, 0x8100000, v220
    v_add_u32 v227, 0x8180000, v220
    v_add_u32 v228, 0x10000000, v220
    v_add_u32 v229, 0x10080000, v220
    v_add_u32 v230, 0x10100000, v220
    v_add_u32 v231, 0x10180000, v220
    v_add_u32 v196, 0x18000000, v220
    v_add_u32 v197, 0x18080000, v220
    v_add_u32 v198, 0x18100000, v220
    v_add_u32 v199, 0x18180000, v220
    v_mov_b32 v62, s89
    s_mov_b32 s94, 0xc003c003
    s_mov_b32 s93, 0
    s_mov_b32 exec_lo, 0x0f0f0f0f
    s_mov_b32 exec_hi, 0x0f0f0f0f
    s_branch K_POLL
K_SAFE:
    s_waitcnt vmcnt(0) lgkmcnt(0)
    v_mov_b32 v4, 0
    v_mov_b32 v5, 0
    v_mov_b32 v6, 0
    v_mov_b32 v7, 0
    v_mov_b32 v8, 0
    v_mov_b32 v9, 0
    v_mov_b32 v10, 0
    v_mov_b32 v11, 0
    v_mov_b32 v12, 0
    v_mov_b32 v13, 0
    v_mov_b32 v14, 0
    v_mov_b32 v15, 0
    v_mov_b32 v16, 0
    v_mov_b32 v17, 0
    v_mov_b32 v18, 0
    v_mov_b32 v19, 0
    v_mov_b32 v20, 0
    v_mov_b32 v21, 0
    v_mov_b32 v22, 0
    v_mov_b32 v23, 0
    v_mov_b32 v24, 0
    v_mov_b32 v25, 0
    v_mov_b32 v26, 0
    v_mov_b32 v27, 0
    v_mov_b32 v28, 0
    v_mov_b32 v29, 0
    v_mov_b32 v30, 0
    v_mov_b32 v31, 0
    v_mov_b32 v32, 0
    v_mov_b32 v33, 0
    v_mov_b32 v34, 0
    v_mov_b32 v35, 0
    s_mov_b32 s92, 0
K_SAFE_L:
    ds_read_u16 v188, v196 offset:0
    ds_read_u16 v190, v197 offset:0
    ds_read_u16 v192, v198 offset:0
    ds_read_u16 v194, v199 offset:0
    ds_read_u16 v237, v236 offset:2
    s_waitcnt lgkmcnt(0)
    s_add_u32 m0, s86, 32768
    s_nop 0
    buffer_load_dwordx4 v[188:189], s[28:31], 0 idxen offen offset:0 sc1 lds
    buffer_load_dwordx4 v[190:191], s[28:31], 0 idxen offen offset:1024 sc1 lds
    buffer_load_dwordx4 v[192:193], s[28:31], 0 idxen offen offset:2048 sc1 lds
    buffer_load_dwordx4 v[194:195], s[28:31], 0 idxen offen offset:3072 sc1 lds
    ds_read_b64 v[186:187], v237 offset:24576
    s_waitcnt vmcnt(0)
    ds_read_b128 v[156:159], v200 offset:32768
    ds_read_b128 v[160:163], v201 offset:32768
    ds_read_b128 v[164:167], v202 offset:32768
    ds_read_b128 v[168:171], v203 offset:32768
    s_waitcnt lgkmcnt(0)
    v_mfma_f32_32x32x8_bf16 v[38:53], v[180:181], v[186:187], v[124:139]
    v_smfmac_f32_32x32x32_bf16 v[38:53], v[172:175], v[156:163], v176
    v_mfma_f32_32x32x8_bf16 v[54:69], v[182:183], v[186:187], v[140:155]
    v_smfmac_f32_32x32x32_bf16 v[54:69], v[172:175], v[164:171], v176
    v_add_u32 v196, 4, v196
    v_add_u32 v197, 4, v197
    v_add_u32 v198, 4, v198
    v_add_u32 v199, 4, v199
    v_add_u32 v236, 4, v236
    v_cmp_lt_u32 vcc, s92, v249
    s_nop 15
    s_mov_b64 exec, vcc
    v_exp_f32 v72, v38
    v_exp_f32 v73, v39
    v_exp_f32 v74, v40
    v_exp_f32 v75, v41
    v_exp_f32 v76, v42
    v_exp_f32 v77, v43
    v_exp_f32 v78, v44
    v_exp_f32 v79, v45
    v_exp_f32 v80, v46
    v_exp_f32 v81, v47
    v_exp_f32 v82, v48
    v_exp_f32 v83, v49
    v_exp_f32 v84, v50
    v_exp_f32 v85, v51
    v_exp_f32 v86, v52
    v_exp_f32 v87, v53
    v_exp_f32 v88, v54
    v_exp_f32 v89, v55
    v_exp_f32 v90, v56
    v_exp_f32 v91, v57
    v_exp_f32 v92, v58
    v_exp_f32 v93, v59
    v_exp_f32 v94, v60
    v_exp_f32 v95, v61
    v_exp_f32 v96, v62
    v_exp_f32 v97, v63
    v_exp_f32 v98, v64
    v_exp_f32 v99, v65
    v_exp_f32 v100, v66
    v_exp_f32 v101, v67
    v_exp_f32 v102, v68
    v_exp_f32 v103, v69
    v_add_f32 v72, 1.0, v72
    v_add_f32 v73, 1.0, v73
    v_add_f32 v74, 1.0, v74
    v_add_f32 v75, 1.0, v75
    v_add_f32 v76, 1.0, v76
    v_add_f32 v77, 1.0, v77
    v_add_f32 v78, 1.0, v78
    v_add_f32 v79, 1.0, v79
    v_add_f32 v80, 1.0, v80
    v_add_f32 v81, 1.0, v81
    v_add_f32 v82, 1.0, v82
    v_add_f32 v83, 1.0, v83
    v_add_f32 v84, 1.0, v84
    v_add_f32 v85, 1.0, v85
    v_add_f32 v86, 1.0, v86
    v_add_f32 v87, 1.0, v87
    v_add_f32 v88, 1.0, v88
    v_add_f32 v89, 1.0, v89
    v_add_f32 v90, 1.0, v90
    v_add_f32 v91, 1.0, v91
    v_add_f32 v92, 1.0, v92
    v_add_f32 v93, 1.0, v93
    v_add_f32 v94, 1.0, v94
    v_add_f32 v95, 1.0, v95
    v_add_f32 v96, 1.0, v96
    v_add_f32 v97, 1.0, v97
    v_add_f32 v98, 1.0, v98
    v_add_f32 v99, 1.0, v99
    v_add_f32 v100, 1.0, v100
    v_add_f32 v101, 1.0, v101
    v_add_f32 v102, 1.0, v102
    v_add_f32 v103, 1.0, v103
    v_rcp_f32 v72, v72
    v_rcp_f32 v73, v73
    v_rcp_f32 v74, v74
    v_rcp_f32 v75, v75
    v_rcp_f32 v76, v76
    v_rcp_f32 v77, v77
    v_rcp_f32 v78, v78
    v_rcp_f32 v79, v79
    v_rcp_f32 v80, v80
    v_rcp_f32 v81, v81
    v_rcp_f32 v82, v82
    v_rcp_f32 v83, v83
    v_rcp_f32 v84, v84
    v_rcp_f32 v85, v85
    v_rcp_f32 v86, v86
    v_rcp_f32 v87, v87
    v_rcp_f32 v88, v88
    v_rcp_f32 v89, v89
    v_rcp_f32 v90, v90
    v_rcp_f32 v91, v91
    v_rcp_f32 v92, v92
    v_rcp_f32 v93, v93
    v_rcp_f32 v94, v94
    v_rcp_f32 v95, v95
    v_rcp_f32 v96, v96
    v_rcp_f32 v97, v97
    v_rcp_f32 v98, v98
    v_rcp_f32 v99, v99
    v_rcp_f32 v100, v100
    v_rcp_f32 v101, v101
    v_rcp_f32 v102, v102
    v_rcp_f32 v103, v103
    v_fmac_f32 v4, v38, v72
    v_fmac_f32 v5, v39, v73
    v_fmac_f32 v6, v40, v74
    v_fmac_f32 v7, v41, v75
    v_fmac_f32 v8, v42, v76
    v_fmac_f32 v9, v43, v77
    v_fmac_f32 v10, v44, v78
    v_fmac_f32 v11, v45, v79
    v_fmac_f32 v12, v46, v80
    v_fmac_f32 v13, v47, v81
    v_fmac_f32 v14, v48, v82
    v_fmac_f32 v15, v49, v83
    v_fmac_f32 v16, v50, v84
    v_fmac_f32 v17, v51, v85
    v_fmac_f32 v18, v52, v86
    v_fmac_f32 v19, v53, v87
    v_fmac_f32 v20, v54, v88
    v_fmac_f32 v21, v55, v89
    v_fmac_f32 v22, v56, v90
    v_fmac_f32 v23, v57, v91
    v_fmac_f32 v24, v58, v92
    v_fmac_f32 v25, v59, v93
    v_fmac_f32 v26, v60, v94
    v_fmac_f32 v27, v61, v95
    v_fmac_f32 v28, v62, v96
    v_fmac_f32 v29, v63, v97
    v_fmac_f32 v30, v64, v98
    v_fmac_f32 v31, v65, v99
    v_fmac_f32 v32, v66, v100
    v_fmac_f32 v33, v67, v101
    v_fmac_f32 v34, v68, v102
    v_fmac_f32 v35, v69, v103
    s_mov_b64 exec, -1
    s_add_u32 s92, s92, 1
    v_cmp_lt_u32 vcc, s92, v249
    s_cbranch_vccnz K_SAFE_L
    ds_read_b64_tr_b16 v[124:125], v246 offset:0
    ds_read_b64_tr_b16 v[126:127], v246 offset:512
    ds_read_b64_tr_b16 v[128:129], v246 offset:4096
    ds_read_b64_tr_b16 v[130:131], v246 offset:4608
    ds_read_b64_tr_b16 v[132:133], v246 offset:8
    ds_read_b64_tr_b16 v[134:135], v246 offset:520
    ds_read_b64_tr_b16 v[136:137], v246 offset:4104
    ds_read_b64_tr_b16 v[138:139], v246 offset:4616
    ds_read_b64_tr_b16 v[140:141], v177 offset:0
    ds_read_b64_tr_b16 v[142:143], v177 offset:512
    ds_read_b64_tr_b16 v[144:145], v177 offset:4096
    ds_read_b64_tr_b16 v[146:147], v177 offset:4608
    ds_read_b64_tr_b16 v[148:149], v177 offset:8
    ds_read_b64_tr_b16 v[150:151], v177 offset:520
    ds_read_b64_tr_b16 v[152:153], v177 offset:4104
    ds_read_b64_tr_b16 v[154:155], v177 offset:4616
    v_cvt_pk_bf16_f32 v46, v4, v5
    v_cvt_pk_bf16_f32 v47, v6, v7
    v_cvt_pk_bf16_f32 v48, v8, v9
    v_cvt_pk_bf16_f32 v49, v10, v11
    ds_write_b128 v238, v[46:49]
    v_cvt_pk_bf16_f32 v50, v12, v13
    v_cvt_pk_bf16_f32 v51, v14, v15
    v_cvt_pk_bf16_f32 v52, v16, v17
    v_cvt_pk_bf16_f32 v53, v18, v19
    ds_write_b128 v239, v[50:53]
    v_cvt_pk_bf16_f32 v62, v20, v21
    v_cvt_pk_bf16_f32 v63, v22, v23
    v_cvt_pk_bf16_f32 v64, v24, v25
    v_cvt_pk_bf16_f32 v65, v26, v27
    ds_write_b128 v240, v[62:65]
    v_cvt_pk_bf16_f32 v66, v28, v29
    v_cvt_pk_bf16_f32 v67, v30, v31
    v_cvt_pk_bf16_f32 v68, v32, v33
    v_cvt_pk_bf16_f32 v69, v34, v35
    ds_write_b128 v241, v[66:69]
K_LAST:
    s_branch K_JOIN
.section .rodata,"a"
.p2align 6
.amdhsa_kernel standalone__mpnn_edge_mlp__graph_kernel
  .amdhsa_next_free_vgpr 256
  .amdhsa_next_free_sgpr 102
  .amdhsa_accum_offset 256
  .amdhsa_group_segment_fixed_size 0
  .amdhsa_kernarg_size 72
  .amdhsa_user_sgpr_count 2
  .amdhsa_user_sgpr_kernarg_segment_ptr 1
  .amdhsa_system_sgpr_workgroup_id_x 1
.end_amdhsa_kernel
```
